```python
import torch

def _softmax(x, axis=-1):
    return torch.softmax(x, dim=axis)

def _gelu(x):
    return torch.nn.functional.gelu(x, approximate='tanh')

def _silu(x):
    return torch.nn.functional.silu(x)

def _sigmoid(x):
    return torch.sigmoid(x)

def _layernorm(x, axis=-1, eps=1e-05):
    m = x.mean(dim=axis, keepdim=True)
    v = x.var(dim=axis, keepdim=True, unbiased=False)
    return (x - m) / torch.sqrt(v + eps)

def _scatter_add(tgt, idx, src, axis=0):
    return tgt.clone().index_add_(axis, idx, src)

def _segment_sum(src, seg, n):
    out = torch.zeros((n,) + src.shape[1:], dtype=src.dtype)
    return out.index_add_(0, seg, src)

def _pad(x, pw):
    flat = tuple((v for pair in reversed(pw) for v in pair))
    return torch.nn.functional.pad(x, flat)
kernel_name = 'gated_mix__spectral_fnet__mixer_gmlp__prompt'

def setup_inputs():

    _w = lambda a: (lambda t: t.to(torch.bfloat16) if t.is_floating_point() else t)(torch.as_tensor(a))

    def _A_setup():
        B, S, D = (1, 2048, 512)
        ns = torch.arange(S)[:, None] * torch.arange(S)[None, :]
        nd = torch.arange(D)[:, None] * torch.arange(D)[None, :]
        Ws_re = torch.cos(-2.0 * torch.pi * ns / S).to(float)
        Ws_im = torch.sin(-2.0 * torch.pi * ns / S).to(float)
        Wd_re = torch.cos(-2.0 * torch.pi * nd / D).to(float)
        Wd_im = torch.sin(-2.0 * torch.pi * nd / D).to(float)
        return {'x': _w((lambda *s: torch.randn(*s, dtype=torch.bfloat16) * 0.05)(B, S, D)), 'dft_seq_re': _w(Ws_re), 'dft_seq_im': _w(Ws_im), 'dft_hid_re': _w(Wd_re), 'dft_hid_im': _w(Wd_im)}
    _A_in = _A_setup()

    def _B_setup():
        B, S, D, F = (1, 2048, 512, 1792)
        Fh = F // 2
        return {'x': _w((lambda *s: torch.randn(*s, dtype=torch.bfloat16) * 0.05)(B, S, D)), 'w_in': _w((lambda *s: torch.randn(*s, dtype=torch.bfloat16) * 1.6)(D, 2 * Fh)), 'w_sp': _w(0.01 * (lambda *s: torch.randn(*s, dtype=torch.bfloat16) * 1.6)(S, S)), 'b_sp': _w(1.0 + 0.01 * (lambda *s: torch.randn(*s, dtype=torch.bfloat16) * 0.8)(S)), 'w_out': _w((lambda *s: torch.randn(*s, dtype=torch.bfloat16) * 0.8)(Fh, D))}
    _B_in = _B_setup()
    return {'A_x': _A_in['x'], 'A_dft_seq_re': _A_in['dft_seq_re'], 'A_dft_seq_im': _A_in['dft_seq_im'], 'A_dft_hid_re': _A_in['dft_hid_re'], 'A_dft_hid_im': _A_in['dft_hid_im'], 'B_x': _B_in['x'], 'B_w_in': _B_in['w_in'], 'B_w_sp': _B_in['w_sp'], 'B_b_sp': _B_in['b_sp'], 'B_w_out': _B_in['w_out'], 'gate_w': _w((lambda *s: torch.randn(*s, dtype=torch.bfloat16) * 0.05)(512) * 16.0)}

def reference(A_x, A_dft_seq_re, A_dft_seq_im, A_dft_hid_re, A_dft_hid_im, B_x, B_w_in, B_w_sp, B_b_sp, B_w_out, gate_w):

    def _A_ref(x, dft_seq_re, dft_seq_im, dft_hid_re, dft_hid_im):
        a = torch.einsum('bsd,ed->bse', x, dft_hid_re)
        b = torch.einsum('bsd,ed->bse', x, dft_hid_im)
        y = torch.einsum('ts,bse->bte', dft_seq_re, a) - torch.einsum('ts,bse->bte', dft_seq_im, b)
        return y

    def _B_ref(x, w_in, w_sp, b_sp, w_out):
        B, S, D = x.shape
        F = w_in.shape[-1]
        Fh = F // 2
        z = _gelu(torch.einsum('bsd,df->bsf', x, w_in))
        z1 = z[..., :Fh].clone()
        z2 = _layernorm(z[..., Fh:], axis=-1)
        g = torch.einsum('ts,bsf->btf', w_sp, z2) + b_sp[None, :, None]
        return torch.einsum('bsf,fd->bsd', z1 * g, w_out)
    x = A_x
    g = _sigmoid((x * gate_w).sum(-1, keepdims=True))
    a = _A_ref(x, A_dft_seq_re, A_dft_seq_im, A_dft_hid_re, A_dft_hid_im)
    b = _B_ref(x, B_w_in, B_w_sp, B_b_sp, B_w_out)
    return g * a + (1 - g) * b
```

```asm
; @launch grid=(256,1,1) block=(256,1,1) lds=163840
.amdgcn_target "amdgcn-amd-amdhsa--gfx950"
.text
.globl gated_mix__spectral_fnet__mixer_gmlp__prompt_kernel
.p2align 8
.type gated_mix__spectral_fnet__mixer_gmlp__prompt_kernel,@function
gated_mix__spectral_fnet__mixer_gmlp__prompt_kernel:
    s_cmp_ge_u32 s2, 256
    s_cbranch_scc1 L_end
    s_load_dwordx2 s[8:9], s[0:1], 0
    s_load_dwordx2 s[20:21], s[0:1], 48
    s_load_dwordx2 s[24:25], s[0:1], 56
    s_getpc_b64 s[4:5]
    s_lshr_b32 s77, s2, 3
    s_mul_i32 s76, s77, 7
    v_min_u32 v15, 6, v0
    v_add_lshl_u32 v15, v15, s76, 7
    v_min_u32 v15, 28244, v15
    v_lshrrev_b32 v14, 6, v0
    global_load_dword v27, v15, s[4:5]
    v_readfirstlane_b32 s54, v14
    v_and_b32 v0, 63, v0
    s_lshr_b32 s3, s2, 5
    s_and_b32 s76, s2, 6
    s_lshl_b32 s76, s76, 2
    s_add_u32 s52, s76, s3
    s_and_b32 s79, s77, 3
    v_lshlrev_b32 v1, 4, v0
    s_lshl_b32 s76, s3, 5
    v_xor_b32 v14, s76, v1
    v_add_u32 v226, 64, v14
    v_add_u32 v227, 48, v14
    v_add_u32 v228, 32, v14
    v_add_u32 v229, 16, v14
    s_mov_b32 s10, 2097216
    s_mov_b32 s11, 0x20000
    s_lshl_b32 s80, s54, 19
    s_lshl_b32 s76, s52, 12
    s_add_u32 s80, s80, s76
    s_mul_i32 s87, s54, 16656
    s_waitcnt lgkmcnt(0)
    s_sub_u32 s8, s8, 64
    s_subb_u32 s9, s9, 0
    s_xor_b32 s88, s79, 0
    s_lshl_b32 s89, s88, 17
    s_add_u32 s89, s89, s80
    s_mul_i32 s88, s88, 4160
    s_add_u32 m0, s88, s87
    s_nop 0
    buffer_load_dwordx4 v226, s[8:11], s89 offen lds
    buffer_load_dwordx4 v227, s[8:11], s89 offen offset:1040 lds
    buffer_load_dwordx4 v228, s[8:11], s89 offen offset:2080 lds
    buffer_load_dwordx4 v229, s[8:11], s89 offen offset:3120 lds
    s_mov_b32 s22, 1835008
    s_mov_b32 s23, 0x20000
    s_lshl_b32 s76, s52, 2
    s_add_u32 s76, s76, s79
    s_lshl_b32 s76, s76, 2
    s_add_u32 s76, s76, s54
    s_mul_i32 s76, s76, 3584
    s_and_b32 s78, s2, 1
    s_mul_i32 s78, s78, 896
    s_add_u32 s76, s76, s78
    v_lshrrev_b32 v14, 3, v0
    v_mul_u32_u24 v14, 768, v14
    v_lshl_add_u32 v14, v0, 7, v14
    s_mov_b64 exec, 0x7f7f
    buffer_load_dword v27, v14, s[20:23], s76 offen
    s_mov_b64 exec, -1
    s_mov_b32 s26, 8388608
    s_mov_b32 s27, 0x20000
    s_load_dwordx2 s[12:13], s[0:1], 24
    s_load_dwordx2 s[16:17], s[0:1], 32
    s_load_dwordx2 s[36:37], s[0:1], 104
    s_load_dwordx2 s[40:41], s[0:1], 96
    s_load_dwordx2 s[28:29], s[0:1], 72
    s_load_dwordx2 s[32:33], s[0:1], 88
    s_load_dwordx2 s[44:45], s[0:1], 64
    s_load_dwordx2 s[48:49], s[0:1], 80
    s_memrealtime s[56:57]
    s_xor_b32 s88, s79, 1
    s_lshl_b32 s89, s88, 17
    s_add_u32 s89, s89, s80
    s_mul_i32 s88, s88, 4160
    s_add_u32 m0, s88, s87
    s_nop 0
    buffer_load_dwordx4 v226, s[8:11], s89 offen lds
    buffer_load_dwordx4 v227, s[8:11], s89 offen offset:1040 lds
    buffer_load_dwordx4 v228, s[8:11], s89 offen offset:2080 lds
    buffer_load_dwordx4 v229, s[8:11], s89 offen offset:3120 lds
    s_and_b32 s76, s2, 1
    s_lshl_b32 s53, s76, 2
    s_add_u32 s53, s53, s79
    s_mov_b32 s55, s54
    s_lshl_b32 s6, s54, 12
    s_lshl_b32 s58, s3, 1
    s_lshl_b32 s59, s54, 10
    v_and_b32 v3, 15, v0
    v_lshrrev_b32 v4, 4, v0
    s_mov_b32 s14, 524352
    s_mov_b32 s15, 0x20000
    s_mov_b32 s18, 524352
    s_mov_b32 s19, 0x20000
    s_mov_b32 s30, 917504
    s_mov_b32 s31, 0x20000
    s_mov_b32 s34, 2097152
    s_mov_b32 s35, 0x20000
    s_mov_b32 s38, 16777216
    s_mov_b32 s39, 0x20000
    s_mov_b32 s42, 256
    s_mov_b32 s43, 0x20000
    s_mov_b32 s46, 4096
    s_mov_b32 s47, 0x20000
    s_mov_b32 s50, 1088
    s_mov_b32 s51, 0x20000
    s_waitcnt lgkmcnt(0)
    s_or_b32 s76, s2, s54
    s_cbranch_scc1 L_notag
    s_or_b32 s56, s56, 1
    s_mul_i32 s76, s56, 0x9e3779b1
    s_add_u32 s57, s57, s76
    v_mov_b32 v18, s56
    v_mov_b32 v19, s57
    s_mov_b64 exec, 1
    buffer_store_dwordx2 v[18:19], off, s[40:43], 0 sc1
    s_mov_b64 exec, -1
L_notag:
    s_cmp_lg_u32 s54, 0
    s_cbranch_scc1 L_notlb
    v_lshlrev_b32 v26, 21, v0
    s_mov_b64 exec, 0xff
    buffer_load_dword v27, v26, s[36:39], 0 offen offset:128 sc1
    buffer_load_dword v27, v26, s[24:27], 0 offen offset:128 sc1
    buffer_load_dword v27, v26, s[44:47], 0 offen offset:128 sc1
    s_mov_b64 exec, -1
L_notlb:
    s_lshl_b32 s76, s54, 7
    v_add_u32 v15, s76, v4
    v_mul_u32_u24 v16, 3584, v15
    s_xor_b32 s77, s53, 1
    s_mul_i32 s76, s77, 224
    s_and_b32 s77, s77, 1
    s_mul_i32 s70, s77, 384
    s_add_u32 s70, s70, 1600
    s_lshl_b32 s78, s77, 5
    s_sub_u32 s76, s76, s78
    s_add_u32 s76, s76, 1792
    s_and_b32 s77, s54, 1
    s_lshl_b32 s77, s77, 3
    v_lshl_add_u32 v14, v4, 1, s77
    v_xor_b32 v14, v14, v3
    v_lshlrev_b32 v14, 4, v14
    v_add3_u32 v8, v14, v16, s76
    v_add_u32 v9, 13312, v8
    v_add_u32 v13, 13312, v9
    v_add_u32 v6, 13312, v13
    s_xor_b32 s76, s3, 0
    s_mul_i32 s90, s76, 57344
    s_xor_b32 s76, s3, 1
    s_mul_i32 s91, s76, 57344
    s_xor_b32 s76, s3, 2
    s_mul_i32 s92, s76, 57344
    s_xor_b32 s76, s3, 3
    s_mul_i32 s93, s76, 57344
    s_xor_b32 s76, s3, 4
    s_mul_i32 s94, s76, 57344
    s_xor_b32 s76, s3, 5
    s_mul_i32 s95, s76, 57344
    s_xor_b32 s76, s3, 6
    s_mul_i32 s96, s76, 57344
    s_xor_b32 s76, s3, 7
    s_mul_i32 s97, s76, 57344
    s_sub_u32 s12, s12, 64
    s_subb_u32 s13, s13, 0
    s_sub_u32 s16, s16, 64
    s_subb_u32 s17, s17, 0
    s_sub_u32 s48, s48, 64
    s_subb_u32 s49, s49, 0
    v_lshrrev_b32 v14, 1, v4
    v_lshlrev_b32 v14, 10, v14
    v_and_b32 v15, 1, v4
    v_lshl_add_u32 v14, v15, 9, v14
    v_lshl_add_u32 v14, v3, 4, v14
    s_and_b32 s76, s52, 1
    s_lshl_b32 s76, s76, 8
    v_add_u32 v12, s76, v14
    s_lshl_b32 s76, s53, 2
    s_add_u32 s76, s76, s54
    s_lshl_b32 s83, s76, 17
    s_lshl_b32 s75, s76, 8
    s_add_u32 s75, s75, 13172736
    s_lshr_b32 s76, s52, 1
    s_lshl_b32 s76, s76, 11
    s_add_u32 s84, s83, s76
    s_xor_b32 s84, s84, 524288
    s_lshl_b32 s76, s52, 2
    s_add_u32 s76, s76, s55
    s_mul_i32 s76, s76, 28672
    s_add_u32 s76, s76, 4194304
    s_lshl_b32 s77, s53, 10
    s_add_u32 s85, s76, s77
    s_lshl_b32 s77, s53, 9
    s_add_u32 s86, s76, s77
    s_add_u32 s86, s86, 24576
    s_mov_b32 s66, -1
    s_mov_b32 s67, 0
    v_lshrrev_b32 v14, 2, v3
    v_lshl_add_u32 v15, v4, 4, v14
    v_lshlrev_b32 v15, 8, v15
    v_and_b32 v16, 3, v3
    v_lshl_add_u32 v15, v16, 3, v15
    v_and_b32 v16, 1, v4
    v_lshl_add_u32 v16, v16, 2, v14
    s_and_b32 s77, s53, 1
    s_and_b32 s78, s54, 1
    s_mul_i32 s76, s78, 6
    s_add_u32 s76, s76, s77
    s_lshl_b32 s78, s78, 1
    s_sub_u32 s78, 1, s78
    s_lshl_b32 s77, s77, 1
    s_sub_u32 s77, 1, s77
    s_mul_i32 s77, s77, 1
    v_xor_b32 v17, s76, v16
    v_lshl_add_u32 v220, v17, 5, v15
    s_add_u32 s4, s76, s77
    v_xor_b32 v17, s4, v16
    v_lshl_add_u32 v232, v17, 5, v15
    s_add_u32 s76, s76, s78
    v_xor_b32 v17, s76, v16
    v_lshl_add_u32 v221, v17, 5, v15
    s_add_u32 s4, s76, s77
    v_xor_b32 v17, s4, v16
    v_lshl_add_u32 v233, v17, 5, v15
    s_add_u32 s76, s76, s78
    v_xor_b32 v17, s76, v16
    v_lshl_add_u32 v222, v17, 5, v15
    s_add_u32 s4, s76, s77
    v_xor_b32 v17, s4, v16
    v_lshl_add_u32 v234, v17, 5, v15
    s_add_u32 s76, s76, s78
    v_xor_b32 v17, s76, v16
    v_lshl_add_u32 v223, v17, 5, v15
    s_add_u32 s4, s76, s77
    v_xor_b32 v17, s4, v16
    v_lshl_add_u32 v235, v17, 5, v15
    v_mul_u32_u24 v14, 1040, v3
    v_lshl_add_u32 v225, v4, 8, v14
    s_mul_i32 s76, s54, 16656
    v_add_u32 v20, s76, v225
    s_xor_b32 s77, s54, 1
    s_mul_i32 s76, s77, 16656
    v_add_u32 v18, s76, v225
    s_mul_i32 s76, s77, 3072
    s_add_u32 s76, s76, 151552
    v_add_u32 v230, s76, v1
    s_mul_i32 s76, s54, 3072
    s_add_u32 s76, s76, 151552
    v_add_u32 v231, s76, v1
    v_mul_u32_u24 v14, 4160, v3
    v_lshrrev_b32 v15, 2, v3
    v_lshl_add_u32 v14, v15, 4, v14
    v_lshl_add_u32 v14, v4, 8, v14
    s_mul_i32 s76, s55, 1040
    v_add_u32 v21, s76, v14
    s_xor_b32 s77, s55, 1
    s_mul_i32 s76, s77, 1040
    v_add_u32 v19, s76, v14
    s_lshl_b32 s7, s53, 15
    s_add_u32 s7, s7, s6
    v_cmp_gt_u32 vcc, 32, v0
    v_mov_b32 v14, s16
    v_mov_b32 v15, s12
    v_cndmask_b32 v14, v14, v15, vcc
    v_mov_b32 v16, s17
    v_mov_b32 v15, s13
    v_cndmask_b32 v16, v16, v15, vcc
    v_subrev_u32 v15, 64, v226
    v_and_b32 v15, 511, v15
    v_add3_u32 v15, v15, 64, s7
    v_add_co_u32 v238, vcc, v14, v15
    s_nop 1
    v_addc_co_u32 v239, vcc, 0, v16, vcc
    v_and_b32 v14, 1, v3
    v_cmp_eq_u32 vcc, 1, v14
    v_and_b32 v14, 1, v4
    s_nop 0
    v_cndmask_b32 v15, v14, v4, vcc
    v_add_u32 v14, 2, v14
    v_add_u32 v16, v4, v3
    v_and_b32 v16, 3, v16
    v_cndmask_b32 v14, v14, v16, vcc
    v_mul_u32_u24 v16, 1040, v3
    v_lshl_add_u32 v225, v15, 8, v16
    v_lshl_add_u32 v236, v14, 8, v16
    s_lshl_b32 s76, s54, 2
    v_add_u32 v15, s76, v4
    v_mul_u32_u24 v15, 139264, v15
    v_lshl_add_u32 v7, v3, 4, v15
    s_mov_b32 s76, 149904
    v_lshl_add_u32 v224, v4, 8, s76
    v_lshrrev_b32 v15, 5, v0
    v_bfe_u32 v16, v0, 3, 2
    v_xor_b32 v16, v16, v15
    v_lshlrev_b32 v16, 8, v16
    v_lshl_add_u32 v16, v15, 19, v16
    s_and_b32 s76, s58, 7
    v_and_b32 v14, 7, v0
    v_xor_b32 v14, s76, v14
    v_lshl_add_u32 v14, v14, 4, v16
    v_add_u32 v10, s59, v14
    v_add_u32 v28, 1047536, v10
    v_add_u32 v29, 1047536, v28
    v_add_u32 v2, 1047536, v29
    s_lshl_b32 s76, s52, 2
    s_add_u32 s76, s76, s55
    s_lshl_b32 s72, s76, 12
    s_lshr_b32 s76, s58, 3
    s_lshl_b32 s76, s76, 7
    s_add_u32 s72, s72, s76
    s_and_b32 s76, s53, 1
    s_lshl_b32 s77, s76, 22
    s_add_u32 s72, s72, s77
    s_mul_i32 s77, s76, 4160
    s_mul_i32 s78, s54, 16656
    s_add_u32 s73, s78, s77
    s_sub_u32 s74, s78, s77
    s_add_u32 s74, s74, 4160
    v_lshrrev_b32 v14, 1, v3
    v_mul_u32_u24 v14, 1040, v14
    v_and_b32 v15, 1, v3
    v_lshl_add_u32 v14, v15, 9, v14
    v_lshrrev_b32 v16, 1, v4
    v_xor_b32 v16, v16, v15
    v_lshl_add_u32 v14, v16, 7, v14
    v_and_b32 v15, 1, v4
    v_lshl_add_u32 v14, v15, 3, v14
    v_add_u32 v11, s78, v14
    v_and_b32 v14, 1, v3
    v_cmp_ne_u32 s[60:61], 0, v14
    v_and_b32 v14, 2, v3
    v_cmp_ne_u32 s[62:63], 0, v14
    v_cmp_gt_u32 s[64:65], 4, v3
    v_cmp_eq_u32 s[68:69], 0, v3
    v_and_b32 v17, 3, v3
    v_lshl_add_u32 v17, v4, 2, v17
    v_lshlrev_b32 v160, 4, v17
    s_lshl_b32 s76, s52, 13
    s_lshl_b32 s77, s54, 8
    s_add_u32 s81, s76, s77
    s_add_u32 s81, s81, 12582912
    v_lshlrev_b32 v14, 2, v4
    v_add_u32 v15, 0, v14
    v_mul_u32_u24 v15, v15, v3
    v_and_b32 v15, 15, v15
    v_cvt_f32_u32 v15, v15
    v_mul_f32 v15, 0x3d800000, v15
    v_cos_f32 v108, v15
    v_sin_f32 v112, v15
    v_add_u32 v15, 1, v14
    v_mul_u32_u24 v15, v15, v3
    v_and_b32 v15, 15, v15
    v_cvt_f32_u32 v15, v15
    v_mul_f32 v15, 0x3d800000, v15
    v_cos_f32 v109, v15
    v_sin_f32 v113, v15
    v_add_u32 v15, 2, v14
    v_mul_u32_u24 v15, v15, v3
    v_and_b32 v15, 15, v15
    v_cvt_f32_u32 v15, v15
    v_mul_f32 v15, 0x3d800000, v15
    v_cos_f32 v110, v15
    v_sin_f32 v114, v15
    v_add_u32 v15, 3, v14
    v_mul_u32_u24 v15, v15, v3
    v_and_b32 v15, 15, v15
    v_cvt_f32_u32 v15, v15
    v_mul_f32 v15, 0x3d800000, v15
    v_cos_f32 v111, v15
    v_sin_f32 v115, v15
    v_cvt_pk_bf16_f32 v240, v108, v109
    v_cvt_pk_bf16_f32 v241, v110, v111
    v_cvt_pk_bf16_f32 v242, v112, v113
    v_cvt_pk_bf16_f32 v243, v114, v115
    v_xor_b32 v244, 0x80008000, v242
    v_xor_b32 v245, 0x80008000, v243
    v_mov_b32 v246, v240
    v_mov_b32 v247, v241
    v_mov_b32 v248, v240
    v_mov_b32 v249, v241
    v_mov_b32 v250, v244
    v_mov_b32 v251, v245
    v_mov_b32 v252, v244
    v_mov_b32 v253, v245
    v_xor_b32 v254, 0x80008000, v240
    v_xor_b32 v255, 0x80008000, v241
    s_xor_b32 s88, s79, 2
    s_lshl_b32 s89, s88, 17
    s_add_u32 s89, s89, s80
    s_mul_i32 s88, s88, 4160
    s_add_u32 m0, s88, s87
    s_nop 0
    buffer_load_dwordx4 v226, s[8:11], s89 offen lds
    buffer_load_dwordx4 v227, s[8:11], s89 offen offset:1040 lds
    buffer_load_dwordx4 v228, s[8:11], s89 offen offset:2080 lds
    buffer_load_dwordx4 v229, s[8:11], s89 offen offset:3120 lds
    s_xor_b32 s88, s79, 3
    s_lshl_b32 s89, s88, 17
    s_add_u32 s89, s89, s80
    s_mul_i32 s88, s88, 4160
    s_add_u32 m0, s88, s87
    s_nop 0
    buffer_load_dwordx4 v226, s[8:11], s89 offen lds
    buffer_load_dwordx4 v227, s[8:11], s89 offen offset:1040 lds
    buffer_load_dwordx4 v228, s[8:11], s89 offen offset:2080 lds
    buffer_load_dwordx4 v229, s[8:11], s89 offen offset:3120 lds
    s_add_u32 m0, s6, 66624
    s_nop 0
    buffer_load_dwordx4 v8, s[20:23], s90 offen lds
    buffer_load_dwordx4 v9, s[20:23], s90 offen offset:1024 lds
    buffer_load_dwordx4 v13, s[20:23], s90 offen offset:2048 lds
    buffer_load_dwordx4 v6, s[20:23], s90 offen offset:3072 lds
    s_add_u32 m0, s6, 83280
    s_nop 0
    buffer_load_dwordx4 v8, s[20:23], s91 offen lds
    buffer_load_dwordx4 v9, s[20:23], s91 offen offset:1024 lds
    buffer_load_dwordx4 v13, s[20:23], s91 offen offset:2048 lds
    buffer_load_dwordx4 v6, s[20:23], s91 offen offset:3072 lds
    s_lshl_b32 s88, s52, 4
    s_and_b32 s89, s53, 3
    s_lshl_b32 s89, s89, 2
    s_add_u32 s88, s88, s89
    s_add_u32 s88, s88, s54
    s_and_b32 s4, s2, 1
    v_lshlrev_b32 v88, 7, v0
    s_mul_i32 s89, s88, 3584
    s_mul_i32 s5, s4, 896
    s_add_u32 s89, s89, s5
    s_mov_b64 exec, 0x7f
    s_lshl_b32 s89, s88, 8
    s_lshl_b32 s5, s4, 17
    s_add_u32 s89, s89, s5
    s_and_b32 s5, s88, 6
    s_cmp_eq_u32 s5, 2
    s_cselect_b32 s5, 0x100000, s89
    s_cselect_b32 s89, s89, 0x100000
    s_sub_u32 s89, s89, 512
    s_mov_b64 exec, 3
    buffer_load_dword v90, v88, s[12:15], s5 offen offset:64
    buffer_load_dword v90, v88, s[16:19], s89 offen offset:64
    s_mov_b64 exec, 0xff
    v_lshrrev_b32 v88, 2, v0
    v_lshlrev_b32 v88, 10, v88
    v_and_b32 v89, 3, v0
    v_lshl_add_u32 v88, v89, 7, v88
    s_lshl_b32 s89, s88, 11
    s_lshl_b32 s5, s4, 9
    s_add_u32 s89, s89, s5
    buffer_load_dword v90, v88, s[28:31], s89 offen
    s_mov_b64 exec, -1
    s_mov_b32 m0, 149904
    s_nop 0
    buffer_load_dwordx4 v226, s[48:51], 0 offen lds
    s_mov_b32 s50, 16384
    s_waitcnt vmcnt(12)
    s_barrier
    s_add_u32 m0, s6, 99936
    s_nop 0
    buffer_load_dwordx4 v8, s[20:23], s92 offen lds
    buffer_load_dwordx4 v9, s[20:23], s92 offen offset:1024 lds
    buffer_load_dwordx4 v13, s[20:23], s92 offen offset:2048 lds
    buffer_load_dwordx4 v6, s[20:23], s92 offen offset:3072 lds
    ds_read_b128 a[0:3], v20 offset:0
    ds_read_b128 a[64:67], v18 offset:0
    ds_read_b128 a[4:7], v20 offset:16
    ds_read_b128 a[68:71], v18 offset:16
    s_waitcnt vmcnt(12)
    s_barrier
    v_add_u32 v232, 66624, v232
    v_add_u32 v233, 66624, v233
    v_add_u32 v234, 66624, v234
    v_add_u32 v235, 66624, v235
    ds_read_b64_tr_b16 v[172:173], v232 offset:0
    ds_read_b64_tr_b16 v[174:175], v232 offset:1024
    ds_read_b64_tr_b16 v[176:177], v233 offset:0
    ds_read_b64_tr_b16 v[178:179], v233 offset:1024
    ds_read_b64_tr_b16 v[180:181], v234 offset:0
    ds_read_b64_tr_b16 v[182:183], v234 offset:1024
    ds_read_b64_tr_b16 v[184:185], v235 offset:0
    ds_read_b64_tr_b16 v[186:187], v235 offset:1024
    ds_read_b64_tr_b16 v[188:189], v232 offset:2048
    ds_read_b64_tr_b16 v[190:191], v232 offset:3072
    ds_read_b64_tr_b16 v[192:193], v233 offset:2048
    ds_read_b64_tr_b16 v[194:195], v233 offset:3072
    ds_read_b64_tr_b16 v[196:197], v234 offset:2048
    ds_read_b64_tr_b16 v[198:199], v234 offset:3072
    ds_read_b64_tr_b16 v[200:201], v235 offset:2048
    ds_read_b64_tr_b16 v[202:203], v235 offset:3072
    s_waitcnt lgkmcnt(8)
    s_waitcnt vmcnt(8)
    s_barrier
    v_mfma_f32_16x16x32_bf16 v[60:63], a[0:3], v[172:175], 0
    ds_read_b128 a[8:11], v20 offset:32
    ds_read_b128 a[72:75], v18 offset:32
    s_add_u32 m0, s6, 116592
    s_nop 0
    buffer_load_dwordx4 v8, s[20:23], s93 offen lds
    v_mfma_f32_16x16x32_bf16 v[84:87], a[64:67], v[172:175], 0
    ds_read_b128 a[12:15], v20 offset:48
    ds_read_b128 a[76:79], v18 offset:48
    v_mfma_f32_16x16x32_bf16 v[64:67], a[0:3], v[176:179], 0
    ds_read_b128 a[16:19], v20 offset:64
    ds_read_b128 a[80:83], v18 offset:64
    buffer_load_dwordx4 v9, s[20:23], s93 offen offset:1024 lds
    v_mfma_f32_16x16x32_bf16 v[80:83], a[64:67], v[176:179], 0
    ds_read_b64_tr_b16 v[204:205], v232 offset:16656
    ds_read_b64_tr_b16 v[206:207], v232 offset:17680
    v_mfma_f32_16x16x32_bf16 v[68:71], a[0:3], v[180:183], 0
    ds_read_b64_tr_b16 v[208:209], v233 offset:16656
    ds_read_b64_tr_b16 v[210:211], v233 offset:17680
    v_mfma_f32_16x16x32_bf16 v[76:79], a[64:67], v[180:183], 0
    ds_read_b64_tr_b16 v[212:213], v234 offset:16656
    ds_read_b64_tr_b16 v[214:215], v234 offset:17680
    v_mfma_f32_16x16x32_bf16 v[72:75], a[0:3], v[184:187], 0
    ds_read_b64_tr_b16 v[216:217], v235 offset:16656
    ds_read_b64_tr_b16 v[218:219], v235 offset:17680
    buffer_load_dwordx4 v13, s[20:23], s93 offen offset:2048 lds
    s_waitcnt lgkmcnt(14)
    v_mfma_f32_16x16x32_bf16 v[60:63], a[4:7], v[188:191], v[60:63]
    ds_read_b128 a[20:23], v20 offset:80
    ds_read_b128 a[84:87], v18 offset:80
    v_mfma_f32_16x16x32_bf16 v[84:87], a[68:71], v[188:191], v[84:87]
    ds_read_b128 a[24:27], v20 offset:96
    ds_read_b128 a[88:91], v18 offset:96
    buffer_load_dwordx4 v6, s[20:23], s93 offen offset:3072 lds
    v_mfma_f32_16x16x32_bf16 v[64:67], a[4:7], v[192:195], v[64:67]
    ds_read_b128 a[28:31], v20 offset:112
    ds_read_b128 a[92:95], v18 offset:112
    v_mfma_f32_16x16x32_bf16 v[80:83], a[68:71], v[192:195], v[80:83]
    ds_read_b64_tr_b16 v[172:173], v232 offset:18704
    ds_read_b64_tr_b16 v[174:175], v232 offset:19728
    s_add_u32 m0, s6, 133248
    s_nop 0
    buffer_load_dwordx4 v8, s[20:23], s94 offen lds
    v_mfma_f32_16x16x32_bf16 v[68:71], a[4:7], v[196:199], v[68:71]
    ds_read_b64_tr_b16 v[176:177], v233 offset:18704
    ds_read_b64_tr_b16 v[178:179], v233 offset:19728
    v_mfma_f32_16x16x32_bf16 v[76:79], a[68:71], v[196:199], v[76:79]
    ds_read_b64_tr_b16 v[180:181], v234 offset:18704
    ds_read_b64_tr_b16 v[182:183], v234 offset:19728
    v_mfma_f32_16x16x32_bf16 v[72:75], a[4:7], v[200:203], v[72:75]
    ds_read_b64_tr_b16 v[184:185], v235 offset:18704
    ds_read_b64_tr_b16 v[186:187], v235 offset:19728
    buffer_load_dwordx4 v9, s[20:23], s94 offen offset:1024 lds
    s_waitcnt lgkmcnt(14)
    s_waitcnt vmcnt(6)
    s_barrier
    v_mfma_f32_16x16x32_bf16 v[60:63], a[8:11], v[204:207], v[60:63]
    ds_read_b128 a[32:35], v20 offset:128
    ds_read_b128 a[96:99], v18 offset:128
    buffer_load_dwordx4 v13, s[20:23], s94 offen offset:2048 lds
    v_mfma_f32_16x16x32_bf16 v[84:87], a[72:75], v[204:207], v[84:87]
    ds_read_b128 a[36:39], v20 offset:144
    ds_read_b128 a[100:103], v18 offset:144
    buffer_load_dwordx4 v6, s[20:23], s94 offen offset:3072 lds
    v_mfma_f32_16x16x32_bf16 v[64:67], a[8:11], v[208:211], v[64:67]
    ds_read_b128 a[40:43], v20 offset:160
    ds_read_b128 a[104:107], v18 offset:160
    s_add_u32 m0, s6, 66624
    s_nop 0
    buffer_load_dwordx4 v8, s[20:23], s95 offen lds
    v_mfma_f32_16x16x32_bf16 v[80:83], a[72:75], v[208:211], v[80:83]
    ds_read_b64_tr_b16 v[188:189], v232 offset:33312
    ds_read_b64_tr_b16 v[190:191], v232 offset:34336
    buffer_load_dwordx4 v9, s[20:23], s95 offen offset:1024 lds
    v_mfma_f32_16x16x32_bf16 v[68:71], a[8:11], v[212:215], v[68:71]
    ds_read_b64_tr_b16 v[192:193], v233 offset:33312
    ds_read_b64_tr_b16 v[194:195], v233 offset:34336
    buffer_load_dwordx4 v13, s[20:23], s95 offen offset:2048 lds
    v_mfma_f32_16x16x32_bf16 v[76:79], a[72:75], v[212:215], v[76:79]
    ds_read_b64_tr_b16 v[196:197], v234 offset:33312
    ds_read_b64_tr_b16 v[198:199], v234 offset:34336
    buffer_load_dwordx4 v6, s[20:23], s95 offen offset:3072 lds
    v_mfma_f32_16x16x32_bf16 v[72:75], a[8:11], v[216:219], v[72:75]
    ds_read_b64_tr_b16 v[200:201], v235 offset:33312
    ds_read_b64_tr_b16 v[202:203], v235 offset:34336
    s_waitcnt lgkmcnt(14)
    v_mfma_f32_16x16x32_bf16 v[60:63], a[12:15], v[172:175], v[60:63]
    ds_read_b128 a[44:47], v20 offset:176
    ds_read_b128 a[108:111], v18 offset:176
    v_mfma_f32_16x16x32_bf16 v[84:87], a[76:79], v[172:175], v[84:87]
    ds_read_b128 a[48:51], v20 offset:192
    ds_read_b128 a[112:115], v18 offset:192
    v_mfma_f32_16x16x32_bf16 v[64:67], a[12:15], v[176:179], v[64:67]
    ds_read_b128 a[52:55], v20 offset:208
    ds_read_b128 a[116:119], v18 offset:208
    v_mfma_f32_16x16x32_bf16 v[80:83], a[76:79], v[176:179], v[80:83]
    ds_read_b64_tr_b16 v[204:205], v232 offset:35360
    ds_read_b64_tr_b16 v[206:207], v232 offset:36384
    v_mfma_f32_16x16x32_bf16 v[68:71], a[12:15], v[180:183], v[68:71]
    ds_read_b64_tr_b16 v[208:209], v233 offset:35360
    ds_read_b64_tr_b16 v[210:211], v233 offset:36384
    v_mfma_f32_16x16x32_bf16 v[76:79], a[76:79], v[180:183], v[76:79]
    ds_read_b64_tr_b16 v[212:213], v234 offset:35360
    ds_read_b64_tr_b16 v[214:215], v234 offset:36384
    v_mfma_f32_16x16x32_bf16 v[72:75], a[12:15], v[184:187], v[72:75]
    ds_read_b64_tr_b16 v[216:217], v235 offset:35360
    ds_read_b64_tr_b16 v[218:219], v235 offset:36384
    s_waitcnt lgkmcnt(14)
    s_waitcnt vmcnt(8)
    s_barrier
    buffer_load_dwordx2 v[162:163], off, s[40:43], 0 sc1
    v_add_u32 v232, 49968, v232
    v_add_u32 v233, 49968, v233
    v_add_u32 v234, 49968, v234
    v_add_u32 v235, 49968, v235
    v_mfma_f32_16x16x32_bf16 v[60:63], a[16:19], v[188:191], v[60:63]
    ds_read_b128 a[56:59], v20 offset:224
    ds_read_b128 a[120:123], v18 offset:224
    s_add_u32 m0, s6, 83280
    s_nop 0
    buffer_load_dwordx4 v8, s[20:23], s96 offen lds
    v_mfma_f32_16x16x32_bf16 v[84:87], a[80:83], v[188:191], v[84:87]
    ds_read_b128 a[60:63], v20 offset:240
    ds_read_b128 a[124:127], v18 offset:240
    buffer_load_dwordx4 v9, s[20:23], s96 offen offset:1024 lds
    v_mfma_f32_16x16x32_bf16 v[64:67], a[16:19], v[192:195], v[64:67]
    ds_read_b128 a[192:195], v21 offset:0
    ds_read_b128 a[128:131], v19 offset:0
    buffer_load_dwordx4 v13, s[20:23], s96 offen offset:2048 lds
    v_mfma_f32_16x16x32_bf16 v[80:83], a[80:83], v[192:195], v[80:83]
    ds_read_b64_tr_b16 v[172:173], v232 offset:0
    ds_read_b64_tr_b16 v[174:175], v232 offset:1024
    buffer_load_dwordx4 v6, s[20:23], s96 offen offset:3072 lds
    v_mfma_f32_16x16x32_bf16 v[68:71], a[16:19], v[196:199], v[68:71]
    ds_read_b64_tr_b16 v[176:177], v233 offset:0
    ds_read_b64_tr_b16 v[178:179], v233 offset:1024
    v_mfma_f32_16x16x32_bf16 v[76:79], a[80:83], v[196:199], v[76:79]
    ds_read_b64_tr_b16 v[180:181], v234 offset:0
    ds_read_b64_tr_b16 v[182:183], v234 offset:1024
    v_mfma_f32_16x16x32_bf16 v[72:75], a[16:19], v[200:203], v[72:75]
    ds_read_b64_tr_b16 v[184:185], v235 offset:0
    ds_read_b64_tr_b16 v[186:187], v235 offset:1024
    s_waitcnt lgkmcnt(14)
    v_mfma_f32_16x16x32_bf16 v[60:63], a[20:23], v[204:207], v[60:63]
    ds_read_b128 a[196:199], v21 offset:16
    ds_read_b128 a[132:135], v19 offset:16
    v_mfma_f32_16x16x32_bf16 v[84:87], a[84:87], v[204:207], v[84:87]
    ds_read_b128 a[200:203], v21 offset:32
    ds_read_b128 a[136:139], v19 offset:32
    v_mfma_f32_16x16x32_bf16 v[64:67], a[20:23], v[208:211], v[64:67]
    ds_read_b128 a[204:207], v21 offset:48
    ds_read_b128 a[140:143], v19 offset:48
    v_mfma_f32_16x16x32_bf16 v[80:83], a[84:87], v[208:211], v[80:83]
    ds_read_b64_tr_b16 v[188:189], v232 offset:2048
    ds_read_b64_tr_b16 v[190:191], v232 offset:3072
    v_mfma_f32_16x16x32_bf16 v[68:71], a[20:23], v[212:215], v[68:71]
    ds_read_b64_tr_b16 v[192:193], v233 offset:2048
    ds_read_b64_tr_b16 v[194:195], v233 offset:3072
    v_mfma_f32_16x16x32_bf16 v[76:79], a[84:87], v[212:215], v[76:79]
    ds_read_b64_tr_b16 v[196:197], v234 offset:2048
    ds_read_b64_tr_b16 v[198:199], v234 offset:3072
    v_mfma_f32_16x16x32_bf16 v[72:75], a[20:23], v[216:219], v[72:75]
    ds_read_b64_tr_b16 v[200:201], v235 offset:2048
    ds_read_b64_tr_b16 v[202:203], v235 offset:3072
    s_waitcnt lgkmcnt(14)
    s_waitcnt vmcnt(9)
    s_barrier
    v_mfma_f32_16x16x32_bf16 v[60:63], a[24:27], v[172:175], v[60:63]
    ds_read_b128 a[208:211], v21 offset:64
    ds_read_b128 a[144:147], v19 offset:64
    s_add_u32 m0, s6, 99936
    s_nop 0
    buffer_load_dwordx4 v8, s[20:23], s97 offen lds
    v_mfma_f32_16x16x32_bf16 v[84:87], a[88:91], v[172:175], v[84:87]
    ds_read_b128 a[212:215], v21 offset:80
    ds_read_b128 a[148:151], v19 offset:80
    buffer_load_dwordx4 v9, s[20:23], s97 offen offset:1024 lds
    v_mfma_f32_16x16x32_bf16 v[64:67], a[24:27], v[176:179], v[64:67]
    ds_read_b128 a[216:219], v21 offset:96
    ds_read_b128 a[152:155], v19 offset:96
    buffer_load_dwordx4 v13, s[20:23], s97 offen offset:2048 lds
    v_mfma_f32_16x16x32_bf16 v[80:83], a[88:91], v[176:179], v[80:83]
    ds_read_b64_tr_b16 v[204:205], v232 offset:16656
    ds_read_b64_tr_b16 v[206:207], v232 offset:17680
    buffer_load_dwordx4 v6, s[20:23], s97 offen offset:3072 lds
    v_lshrrev_b32 v88, 3, v0
    v_lshlrev_b32 v88, 19, v88
    v_and_b32 v89, 7, v0
    v_lshl_add_u32 v88, v89, 7, v88
    s_lshl_b32 s88, s52, 2
    s_and_b32 s89, s53, 3
    s_add_u32 s88, s88, s89
    s_lshl_b32 s88, s88, 12
    s_add_u32 s88, s88, s59
    s_and_b32 s89, s2, 1
    s_lshl_b32 s89, s89, 22
    s_add_u32 s88, s88, s89
    buffer_load_dword v90, v88, s[24:27], s88 offen
    v_mfma_f32_16x16x32_bf16 v[68:71], a[24:27], v[180:183], v[68:71]
    ds_read_b64_tr_b16 v[208:209], v233 offset:16656
    ds_read_b64_tr_b16 v[210:211], v233 offset:17680
    v_mfma_f32_16x16x32_bf16 v[76:79], a[88:91], v[180:183], v[76:79]
    ds_read_b64_tr_b16 v[212:213], v234 offset:16656
    ds_read_b64_tr_b16 v[214:215], v234 offset:17680
    v_mfma_f32_16x16x32_bf16 v[72:75], a[24:27], v[184:187], v[72:75]
    ds_read_b64_tr_b16 v[216:217], v235 offset:16656
    ds_read_b64_tr_b16 v[218:219], v235 offset:17680
    s_waitcnt lgkmcnt(14)
    v_mfma_f32_16x16x32_bf16 v[60:63], a[28:31], v[188:191], v[60:63]
    ds_read_b128 a[220:223], v21 offset:112
    ds_read_b128 a[156:159], v19 offset:112
    v_mfma_f32_16x16x32_bf16 v[84:87], a[92:95], v[188:191], v[84:87]
    ds_read_b128 a[224:227], v21 offset:128
    ds_read_b128 a[160:163], v19 offset:128
    v_mfma_f32_16x16x32_bf16 v[64:67], a[28:31], v[192:195], v[64:67]
    ds_read_b128 a[228:231], v21 offset:144
    ds_read_b128 a[164:167], v19 offset:144
    v_mfma_f32_16x16x32_bf16 v[80:83], a[92:95], v[192:195], v[80:83]
    ds_read_b64_tr_b16 v[172:173], v232 offset:18704
    ds_read_b64_tr_b16 v[174:175], v232 offset:19728
    v_mfma_f32_16x16x32_bf16 v[68:71], a[28:31], v[196:199], v[68:71]
    ds_read_b64_tr_b16 v[176:177], v233 offset:18704
    ds_read_b64_tr_b16 v[178:179], v233 offset:19728
    v_mfma_f32_16x16x32_bf16 v[76:79], a[92:95], v[196:199], v[76:79]
    ds_read_b64_tr_b16 v[180:181], v234 offset:18704
    ds_read_b64_tr_b16 v[182:183], v234 offset:19728
    v_mfma_f32_16x16x32_bf16 v[72:75], a[28:31], v[200:203], v[72:75]
    ds_read_b64_tr_b16 v[184:185], v235 offset:18704
    ds_read_b64_tr_b16 v[186:187], v235 offset:19728
    s_waitcnt lgkmcnt(14)
    s_waitcnt vmcnt(10)
    s_barrier
    v_subrev_u32 v232, 49968, v232
    v_subrev_u32 v233, 49968, v233
    v_subrev_u32 v234, 49968, v234
    v_subrev_u32 v235, 49968, v235
    v_mfma_f32_16x16x32_bf16 v[60:63], a[32:35], v[204:207], v[60:63]
    ds_read_b128 a[232:235], v21 offset:160
    ds_read_b128 a[168:171], v19 offset:160
    v_mfma_f32_16x16x32_bf16 v[84:87], a[96:99], v[204:207], v[84:87]
    ds_read_b128 a[236:239], v21 offset:176
    ds_read_b128 a[172:175], v19 offset:176
    v_mfma_f32_16x16x32_bf16 v[64:67], a[32:35], v[208:211], v[64:67]
    ds_read_b128 a[240:243], v21 offset:192
    ds_read_b128 a[176:179], v19 offset:192
    v_mfma_f32_16x16x32_bf16 v[80:83], a[96:99], v[208:211], v[80:83]
    ds_read_b64_tr_b16 v[188:189], v232 offset:0
    ds_read_b64_tr_b16 v[190:191], v232 offset:1024
    v_mfma_f32_16x16x32_bf16 v[68:71], a[32:35], v[212:215], v[68:71]
    ds_read_b64_tr_b16 v[192:193], v233 offset:0
    ds_read_b64_tr_b16 v[194:195], v233 offset:1024
    v_mfma_f32_16x16x32_bf16 v[76:79], a[96:99], v[212:215], v[76:79]
    ds_read_b64_tr_b16 v[196:197], v234 offset:0
    ds_read_b64_tr_b16 v[198:199], v234 offset:1024
    v_mfma_f32_16x16x32_bf16 v[72:75], a[32:35], v[216:219], v[72:75]
    ds_read_b64_tr_b16 v[200:201], v235 offset:0
    ds_read_b64_tr_b16 v[202:203], v235 offset:1024
    s_waitcnt lgkmcnt(14)
    v_mfma_f32_16x16x32_bf16 v[60:63], a[36:39], v[172:175], v[60:63]
    ds_read_b128 a[244:247], v21 offset:208
    ds_read_b128 a[180:183], v19 offset:208
    v_mfma_f32_16x16x32_bf16 v[84:87], a[100:103], v[172:175], v[84:87]
    ds_read_b128 a[248:251], v21 offset:224
    ds_read_b128 a[184:187], v19 offset:224
    v_mfma_f32_16x16x32_bf16 v[64:67], a[36:39], v[176:179], v[64:67]
    ds_read_b128 a[252:255], v21 offset:240
    ds_read_b128 a[188:191], v19 offset:240
    v_mfma_f32_16x16x32_bf16 v[80:83], a[100:103], v[176:179], v[80:83]
    ds_read_b64_tr_b16 v[204:205], v232 offset:2048
    ds_read_b64_tr_b16 v[206:207], v232 offset:3072
    v_mfma_f32_16x16x32_bf16 v[68:71], a[36:39], v[180:183], v[68:71]
    ds_read_b64_tr_b16 v[208:209], v233 offset:2048
    ds_read_b64_tr_b16 v[210:211], v233 offset:3072
    v_mfma_f32_16x16x32_bf16 v[76:79], a[100:103], v[180:183], v[76:79]
    ds_read_b64_tr_b16 v[212:213], v234 offset:2048
    ds_read_b64_tr_b16 v[214:215], v234 offset:3072
    v_mfma_f32_16x16x32_bf16 v[72:75], a[36:39], v[184:187], v[72:75]
    ds_read_b64_tr_b16 v[216:217], v235 offset:2048
    ds_read_b64_tr_b16 v[218:219], v235 offset:3072
    s_waitcnt lgkmcnt(14)
    s_waitcnt vmcnt(5)
    s_barrier
    v_mfma_f32_16x16x32_bf16 v[60:63], a[40:43], v[188:191], v[60:63]
    ds_read_b64_tr_b16 v[172:173], v232 offset:16656
    ds_read_b64_tr_b16 v[174:175], v232 offset:17680
    v_mfma_f32_16x16x32_bf16 v[84:87], a[104:107], v[188:191], v[84:87]
    ds_read_b64_tr_b16 v[176:177], v233 offset:16656
    ds_read_b64_tr_b16 v[178:179], v233 offset:17680
    v_mfma_f32_16x16x32_bf16 v[64:67], a[40:43], v[192:195], v[64:67]
    ds_read_b64_tr_b16 v[180:181], v234 offset:16656
    ds_read_b64_tr_b16 v[182:183], v234 offset:17680
    v_mfma_f32_16x16x32_bf16 v[80:83], a[104:107], v[192:195], v[80:83]
    ds_read_b64_tr_b16 v[184:185], v235 offset:16656
    ds_read_b64_tr_b16 v[186:187], v235 offset:17680
    v_mfma_f32_16x16x32_bf16 v[68:71], a[40:43], v[196:199], v[68:71]
    v_mfma_f32_16x16x32_bf16 v[76:79], a[104:107], v[196:199], v[76:79]
    v_mfma_f32_16x16x32_bf16 v[72:75], a[40:43], v[200:203], v[72:75]
    s_waitcnt lgkmcnt(8)
    v_mfma_f32_16x16x32_bf16 v[60:63], a[44:47], v[204:207], v[60:63]
    ds_read_b64_tr_b16 v[188:189], v232 offset:18704
    ds_read_b64_tr_b16 v[190:191], v232 offset:19728
    v_mfma_f32_16x16x32_bf16 v[84:87], a[108:111], v[204:207], v[84:87]
    ds_read_b64_tr_b16 v[192:193], v233 offset:18704
    ds_read_b64_tr_b16 v[194:195], v233 offset:19728
    v_mfma_f32_16x16x32_bf16 v[64:67], a[44:47], v[208:211], v[64:67]
    ds_read_b64_tr_b16 v[196:197], v234 offset:18704
    ds_read_b64_tr_b16 v[198:199], v234 offset:19728
    v_mfma_f32_16x16x32_bf16 v[80:83], a[108:111], v[208:211], v[80:83]
    ds_read_b64_tr_b16 v[200:201], v235 offset:18704
    ds_read_b64_tr_b16 v[202:203], v235 offset:19728
    v_mfma_f32_16x16x32_bf16 v[68:71], a[44:47], v[212:215], v[68:71]
    v_mfma_f32_16x16x32_bf16 v[76:79], a[108:111], v[212:215], v[76:79]
    v_mfma_f32_16x16x32_bf16 v[72:75], a[44:47], v[216:219], v[72:75]
    s_waitcnt lgkmcnt(8)
    s_waitcnt vmcnt(1)
    s_barrier
    v_mfma_f32_16x16x32_bf16 v[60:63], a[48:51], v[172:175], v[60:63]
    ds_read_b64_tr_b16 v[204:205], v232 offset:33312
    ds_read_b64_tr_b16 v[206:207], v232 offset:34336
    v_mfma_f32_16x16x32_bf16 v[84:87], a[112:115], v[172:175], v[84:87]
    ds_read_b64_tr_b16 v[208:209], v233 offset:33312
    ds_read_b64_tr_b16 v[210:211], v233 offset:34336
    v_mfma_f32_16x16x32_bf16 v[64:67], a[48:51], v[176:179], v[64:67]
    ds_read_b64_tr_b16 v[212:213], v234 offset:33312
    ds_read_b64_tr_b16 v[214:215], v234 offset:34336
    v_mfma_f32_16x16x32_bf16 v[80:83], a[112:115], v[176:179], v[80:83]
    ds_read_b64_tr_b16 v[216:217], v235 offset:33312
    ds_read_b64_tr_b16 v[218:219], v235 offset:34336
    v_mfma_f32_16x16x32_bf16 v[68:71], a[48:51], v[180:183], v[68:71]
    v_mfma_f32_16x16x32_bf16 v[76:79], a[112:115], v[180:183], v[76:79]
    v_mfma_f32_16x16x32_bf16 v[72:75], a[48:51], v[184:187], v[72:75]
    s_waitcnt lgkmcnt(8)
    v_mfma_f32_16x16x32_bf16 v[60:63], a[52:55], v[188:191], v[60:63]
    ds_read_b64_tr_b16 v[172:173], v232 offset:35360
    ds_read_b64_tr_b16 v[174:175], v232 offset:36384
    v_mfma_f32_16x16x32_bf16 v[84:87], a[116:119], v[188:191], v[84:87]
    ds_read_b64_tr_b16 v[176:177], v233 offset:35360
    ds_read_b64_tr_b16 v[178:179], v233 offset:36384
    v_mfma_f32_16x16x32_bf16 v[64:67], a[52:55], v[192:195], v[64:67]
    ds_read_b64_tr_b16 v[180:181], v234 offset:35360
    ds_read_b64_tr_b16 v[182:183], v234 offset:36384
    v_subrev_u32 v8, s70, v8
    v_subrev_u32 v9, s70, v9
    v_subrev_u32 v13, s70, v13
    v_subrev_u32 v6, s70, v6
    s_add_u32 m0, s6, 116592
    s_nop 0
    buffer_load_dwordx4 v8, s[20:23], s90 offen lds
    v_mfma_f32_16x16x32_bf16 v[80:83], a[116:119], v[192:195], v[80:83]
    ds_read_b64_tr_b16 v[184:185], v235 offset:35360
    ds_read_b64_tr_b16 v[186:187], v235 offset:36384
    v_mfma_f32_16x16x32_bf16 v[68:71], a[52:55], v[196:199], v[68:71]
    v_mfma_f32_16x16x32_bf16 v[76:79], a[116:119], v[196:199], v[76:79]
    buffer_load_dwordx4 v9, s[20:23], s90 offen offset:1024 lds
    v_mfma_f32_16x16x32_bf16 v[72:75], a[52:55], v[200:203], v[72:75]
    s_waitcnt lgkmcnt(8)
    v_mfma_f32_16x16x32_bf16 v[60:63], a[56:59], v[204:207], v[60:63]
    v_mfma_f32_16x16x32_bf16 v[84:87], a[120:123], v[204:207], v[84:87]
    v_mfma_f32_16x16x32_bf16 v[64:67], a[56:59], v[208:211], v[64:67]
    v_mfma_f32_16x16x32_bf16 v[80:83], a[120:123], v[208:211], v[80:83]
    buffer_load_dwordx4 v13, s[20:23], s90 offen offset:2048 lds
    v_mfma_f32_16x16x32_bf16 v[68:71], a[56:59], v[212:215], v[68:71]
    v_mfma_f32_16x16x32_bf16 v[76:79], a[120:123], v[212:215], v[76:79]
    v_mfma_f32_16x16x32_bf16 v[72:75], a[56:59], v[216:219], v[72:75]
    s_waitcnt lgkmcnt(0)
    v_mfma_f32_16x16x32_bf16 v[60:63], a[60:63], v[172:175], v[60:63]
    buffer_load_dwordx4 v6, s[20:23], s90 offen offset:3072 lds
    v_mfma_f32_16x16x32_bf16 v[84:87], a[124:127], v[172:175], v[84:87]
    v_mfma_f32_16x16x32_bf16 v[64:67], a[60:63], v[176:179], v[64:67]
    v_mfma_f32_16x16x32_bf16 v[80:83], a[124:127], v[176:179], v[80:83]
    v_mfma_f32_16x16x32_bf16 v[68:71], a[60:63], v[180:183], v[68:71]
    v_mfma_f32_16x16x32_bf16 v[76:79], a[124:127], v[180:183], v[76:79]
    s_add_u32 m0, s6, 133248
    s_nop 0
    buffer_load_dwordx4 v8, s[20:23], s91 offen lds
    v_mfma_f32_16x16x32_bf16 v[72:75], a[60:63], v[184:187], v[72:75]
    s_nop 3
    ds_write_b128 v230, v[76:79] offset:0
    ds_write_b128 v230, v[80:83] offset:1024
    ds_write_b128 v230, v[84:87] offset:2048
    s_waitcnt lgkmcnt(0)
    s_barrier
    ds_read_b128 v[76:79], v231 offset:0
    ds_read_b128 v[80:83], v231 offset:1024
    ds_read_b128 v[84:87], v231 offset:2048
    s_waitcnt vmcnt(14)
    s_mov_b32 s82, 0
L_tag:
    v_readfirstlane_b32 s56, v162
    v_readfirstlane_b32 s57, v163
    s_cmp_lg_u32 s56, 0
    s_cbranch_scc1 L_tagok
    s_add_u32 s82, s82, 1
    s_cmp_ge_u32 s82, 200000
    s_cbranch_scc1 L_tagok
    buffer_load_dwordx2 v[162:163], off, s[40:43], 0 sc1
    s_waitcnt vmcnt(0)
    s_branch L_tag
L_tagok:
    s_mov_b32 s4, 0xbdd2d3e8
    buffer_load_dwordx4 v9, s[20:23], s91 offen offset:1024 lds
    s_mov_b32 s5, 0xbdd2d3e8
    buffer_load_dwordx4 v13, s[20:23], s91 offen offset:2048 lds
    v_mov_b32 v22, 0xc0135761
    buffer_load_dwordx4 v6, s[20:23], s91 offen offset:3072 lds
    v_mov_b32 v23, 0xc0135761
    v_pk_mul_f32 v[14:15], v[60:61], v[60:61]
    s_add_u32 m0, s6, 66624
    s_nop 0
    buffer_load_dwordx4 v8, s[20:23], s92 offen lds
    v_pk_mul_f32 v[16:17], v[62:63], v[62:63]
    v_pk_fma_f32 v[14:15], v[14:15], s[4:5], v[22:23]
    v_pk_fma_f32 v[16:17], v[16:17], s[4:5], v[22:23]
    v_pk_mul_f32 v[14:15], v[14:15], v[60:61]
    v_pk_mul_f32 v[16:17], v[16:17], v[62:63]
    v_exp_f32 v14, v14
    v_exp_f32 v15, v15
    v_exp_f32 v16, v16
    v_exp_f32 v17, v17
    v_pk_add_f32 v[14:15], v[14:15], 1.0 op_sel_hi:[1,0]
    v_pk_add_f32 v[16:17], v[16:17], 1.0 op_sel_hi:[1,0]
    buffer_load_dwordx4 v9, s[20:23], s92 offen offset:1024 lds
    v_rcp_f32 v14, v14
    v_rcp_f32 v15, v15
    v_rcp_f32 v16, v16
    v_rcp_f32 v17, v17
    v_pk_mul_f32 v[60:61], v[60:61], v[14:15]
    v_pk_mul_f32 v[62:63], v[62:63], v[16:17]
    v_pk_mul_f32 v[14:15], v[64:65], v[64:65]
    v_pk_mul_f32 v[16:17], v[66:67], v[66:67]
    v_pk_fma_f32 v[14:15], v[14:15], s[4:5], v[22:23]
    v_pk_fma_f32 v[16:17], v[16:17], s[4:5], v[22:23]
    v_pk_mul_f32 v[14:15], v[14:15], v[64:65]
    buffer_load_dwordx4 v13, s[20:23], s92 offen offset:2048 lds
    v_pk_mul_f32 v[16:17], v[16:17], v[66:67]
    v_exp_f32 v14, v14
    v_exp_f32 v15, v15
    v_exp_f32 v16, v16
    v_exp_f32 v17, v17
    v_pk_add_f32 v[14:15], v[14:15], 1.0 op_sel_hi:[1,0]
    v_pk_add_f32 v[16:17], v[16:17], 1.0 op_sel_hi:[1,0]
    v_rcp_f32 v14, v14
    v_rcp_f32 v15, v15
    v_rcp_f32 v16, v16
    buffer_load_dwordx4 v6, s[20:23], s92 offen offset:3072 lds
    v_rcp_f32 v17, v17
    v_pk_mul_f32 v[64:65], v[64:65], v[14:15]
    v_pk_mul_f32 v[66:67], v[66:67], v[16:17]
    v_pk_mul_f32 v[14:15], v[68:69], v[68:69]
    v_pk_mul_f32 v[16:17], v[70:71], v[70:71]
    v_pk_fma_f32 v[14:15], v[14:15], s[4:5], v[22:23]
    v_pk_fma_f32 v[16:17], v[16:17], s[4:5], v[22:23]
    v_pk_mul_f32 v[14:15], v[14:15], v[68:69]
    v_pk_mul_f32 v[16:17], v[16:17], v[70:71]
    v_exp_f32 v14, v14
    v_exp_f32 v15, v15
    v_exp_f32 v16, v16
    s_xor_b32 s89, s72, 0
    s_add_u32 m0, s73, 0
    s_nop 0
    buffer_load_dwordx4 v10, s[24:27], s89 offen lds
    v_exp_f32 v17, v17
    v_pk_add_f32 v[14:15], v[14:15], 1.0 op_sel_hi:[1,0]
    v_pk_add_f32 v[16:17], v[16:17], 1.0 op_sel_hi:[1,0]
    v_rcp_f32 v14, v14
    v_rcp_f32 v15, v15
    v_rcp_f32 v16, v16
    v_rcp_f32 v17, v17
    buffer_load_dwordx4 v28, s[24:27], s89 offen offset:1040 lds
    v_pk_mul_f32 v[68:69], v[68:69], v[14:15]
    v_pk_mul_f32 v[70:71], v[70:71], v[16:17]
    v_pk_mul_f32 v[14:15], v[72:73], v[72:73]
    v_pk_mul_f32 v[16:17], v[74:75], v[74:75]
    v_pk_fma_f32 v[14:15], v[14:15], s[4:5], v[22:23]
    v_pk_fma_f32 v[16:17], v[16:17], s[4:5], v[22:23]
    v_pk_mul_f32 v[14:15], v[14:15], v[72:73]
    v_pk_mul_f32 v[16:17], v[16:17], v[74:75]
    v_exp_f32 v14, v14
    v_exp_f32 v15, v15
    v_exp_f32 v16, v16
    buffer_load_dwordx4 v29, s[24:27], s89 offen offset:2080 lds
    v_exp_f32 v17, v17
    v_pk_add_f32 v[14:15], v[14:15], 1.0 op_sel_hi:[1,0]
    v_pk_add_f32 v[16:17], v[16:17], 1.0 op_sel_hi:[1,0]
    v_rcp_f32 v14, v14
    v_rcp_f32 v15, v15
    v_rcp_f32 v16, v16
    v_rcp_f32 v17, v17
    v_pk_mul_f32 v[72:73], v[72:73], v[14:15]
    buffer_load_dwordx4 v2, s[24:27], s89 offen offset:3120 lds
    v_pk_mul_f32 v[74:75], v[74:75], v[16:17]
    s_waitcnt lgkmcnt(0)
    v_pk_mul_f32 v[14:15], v[76:77], v[76:77]
    v_pk_mul_f32 v[16:17], v[78:79], v[78:79]
    v_pk_fma_f32 v[14:15], v[14:15], s[4:5], v[22:23]
    v_pk_fma_f32 v[16:17], v[16:17], s[4:5], v[22:23]
    v_pk_mul_f32 v[14:15], v[14:15], v[76:77]
    v_pk_mul_f32 v[16:17], v[16:17], v[78:79]
    v_exp_f32 v14, v14
    v_exp_f32 v15, v15
    v_exp_f32 v16, v16
    s_xor_b32 s89, s89, 4194304
    s_add_u32 m0, s74, 0
    s_nop 0
    buffer_load_dwordx4 v10, s[24:27], s89 offen lds
    v_exp_f32 v17, v17
    v_pk_add_f32 v[14:15], v[14:15], 1.0 op_sel_hi:[1,0]
    v_pk_add_f32 v[16:17], v[16:17], 1.0 op_sel_hi:[1,0]
    v_rcp_f32 v14, v14
    v_rcp_f32 v15, v15
    v_rcp_f32 v16, v16
    v_rcp_f32 v17, v17
    v_pk_mul_f32 v[76:77], v[76:77], v[14:15]
    buffer_load_dwordx4 v28, s[24:27], s89 offen offset:1040 lds
    v_pk_mul_f32 v[78:79], v[78:79], v[16:17]
    v_pk_mul_f32 v[14:15], v[80:81], v[80:81]
    v_pk_mul_f32 v[16:17], v[82:83], v[82:83]
    v_pk_fma_f32 v[14:15], v[14:15], s[4:5], v[22:23]
    v_pk_fma_f32 v[16:17], v[16:17], s[4:5], v[22:23]
    v_pk_mul_f32 v[14:15], v[14:15], v[80:81]
    v_pk_mul_f32 v[16:17], v[16:17], v[82:83]
    v_exp_f32 v14, v14
    v_exp_f32 v15, v15
    v_exp_f32 v16, v16
    buffer_load_dwordx4 v29, s[24:27], s89 offen offset:2080 lds
    v_exp_f32 v17, v17
    v_pk_add_f32 v[14:15], v[14:15], 1.0 op_sel_hi:[1,0]
    v_pk_add_f32 v[16:17], v[16:17], 1.0 op_sel_hi:[1,0]
    v_rcp_f32 v14, v14
    v_rcp_f32 v15, v15
    v_rcp_f32 v16, v16
    v_rcp_f32 v17, v17
    v_pk_mul_f32 v[80:81], v[80:81], v[14:15]
    v_pk_mul_f32 v[82:83], v[82:83], v[16:17]
    buffer_load_dwordx4 v2, s[24:27], s89 offen offset:3120 lds
    v_pk_mul_f32 v[14:15], v[84:85], v[84:85]
    v_pk_mul_f32 v[16:17], v[86:87], v[86:87]
    v_pk_fma_f32 v[14:15], v[14:15], s[4:5], v[22:23]
    v_pk_fma_f32 v[16:17], v[16:17], s[4:5], v[22:23]
    v_pk_mul_f32 v[14:15], v[14:15], v[84:85]
    v_pk_mul_f32 v[16:17], v[16:17], v[86:87]
    v_exp_f32 v14, v14
    v_exp_f32 v15, v15
    v_exp_f32 v16, v16
    v_exp_f32 v17, v17
    s_xor_b32 s89, s72, 128
    s_add_u32 m0, s73, 8320
    s_nop 0
    buffer_load_dwordx4 v10, s[24:27], s89 offen lds
    v_pk_add_f32 v[14:15], v[14:15], 1.0 op_sel_hi:[1,0]
    v_pk_add_f32 v[16:17], v[16:17], 1.0 op_sel_hi:[1,0]
    v_rcp_f32 v14, v14
    v_rcp_f32 v15, v15
    v_rcp_f32 v16, v16
    v_rcp_f32 v17, v17
    v_pk_mul_f32 v[84:85], v[84:85], v[14:15]
    v_pk_mul_f32 v[86:87], v[86:87], v[16:17]
    buffer_load_dwordx4 v28, s[24:27], s89 offen offset:1040 lds
    s_bitcmp0_b32 s54, 0
    s_cbranch_scc1 L_ex2
    v_swap_b32 v60, v84
    v_swap_b32 v61, v85
    v_swap_b32 v62, v86
    v_swap_b32 v63, v87
    v_swap_b32 v64, v80
    v_swap_b32 v65, v81
    v_swap_b32 v66, v82
    v_swap_b32 v67, v83
    v_swap_b32 v68, v76
    v_swap_b32 v69, v77
    v_swap_b32 v70, v78
    v_swap_b32 v71, v79
L_ex2:
    v_pk_add_f32 v[14:15], v[60:61], v[64:65]
    v_pk_add_f32 v[16:17], v[62:63], v[66:67]
    v_pk_add_f32 v[14:15], v[14:15], v[68:69]
    v_pk_add_f32 v[16:17], v[16:17], v[70:71]
    v_pk_add_f32 v[14:15], v[14:15], v[72:73]
    v_pk_add_f32 v[16:17], v[16:17], v[74:75]
    v_pk_add_f32 v[14:15], v[14:15], v[76:77]
    v_pk_add_f32 v[16:17], v[16:17], v[78:79]
    v_pk_add_f32 v[14:15], v[14:15], v[80:81]
    v_pk_add_f32 v[16:17], v[16:17], v[82:83]
    buffer_load_dwordx4 v29, s[24:27], s89 offen offset:2080 lds
    v_pk_add_f32 v[14:15], v[14:15], v[84:85]
    v_pk_add_f32 v[16:17], v[16:17], v[86:87]
    s_nop 0
    v_add_f32_dpp v14, v14, v14 row_ror:8 row_mask:0xf bank_mask:0xf
    v_add_f32_dpp v15, v15, v15 row_ror:8 row_mask:0xf bank_mask:0xf
    v_add_f32_dpp v16, v16, v16 row_ror:8 row_mask:0xf bank_mask:0xf
    v_add_f32_dpp v17, v17, v17 row_ror:8 row_mask:0xf bank_mask:0xf
    v_add_f32_dpp v14, v14, v14 row_ror:4 row_mask:0xf bank_mask:0xf
    v_add_f32_dpp v15, v15, v15 row_ror:4 row_mask:0xf bank_mask:0xf
    v_add_f32_dpp v16, v16, v16 row_ror:4 row_mask:0xf bank_mask:0xf
    v_add_f32_dpp v17, v17, v17 row_ror:4 row_mask:0xf bank_mask:0xf
    v_add_f32_dpp v14, v14, v14 row_ror:2 row_mask:0xf bank_mask:0xf
    v_add_f32_dpp v15, v15, v15 row_ror:2 row_mask:0xf bank_mask:0xf
    v_add_f32_dpp v16, v16, v16 row_ror:2 row_mask:0xf bank_mask:0xf
    v_add_f32_dpp v17, v17, v17 row_ror:2 row_mask:0xf bank_mask:0xf
    buffer_load_dwordx4 v2, s[24:27], s89 offen offset:3120 lds
    v_add_f32_dpp v14, v14, v14 row_ror:1 row_mask:0xf bank_mask:0xf
    v_add_f32_dpp v15, v15, v15 row_ror:1 row_mask:0xf bank_mask:0xf
    v_add_f32_dpp v16, v16, v16 row_ror:1 row_mask:0xf bank_mask:0xf
    v_add_f32_dpp v17, v17, v17 row_ror:1 row_mask:0xf bank_mask:0xf
    v_mul_f32 v156, 0x3c124925, v14
    v_mul_f32 v157, 0x3c124925, v15
    v_mul_f32 v158, 0x3c124925, v16
    v_mul_f32 v159, 0x3c124925, v17
    v_pk_add_f32 v[60:61], v[60:61], v[156:157] neg_lo:[0,1] neg_hi:[0,1]
    v_pk_add_f32 v[62:63], v[62:63], v[158:159] neg_lo:[0,1] neg_hi:[0,1]
    v_pk_add_f32 v[64:65], v[64:65], v[156:157] neg_lo:[0,1] neg_hi:[0,1]
    v_pk_add_f32 v[66:67], v[66:67], v[158:159] neg_lo:[0,1] neg_hi:[0,1]
    v_pk_add_f32 v[68:69], v[68:69], v[156:157] neg_lo:[0,1] neg_hi:[0,1]
    s_xor_b32 s89, s89, 4194304
    s_add_u32 m0, s74, 8320
    s_nop 0
    buffer_load_dwordx4 v10, s[24:27], s89 offen lds
    v_pk_add_f32 v[70:71], v[70:71], v[158:159] neg_lo:[0,1] neg_hi:[0,1]
    v_pk_add_f32 v[72:73], v[72:73], v[156:157] neg_lo:[0,1] neg_hi:[0,1]
    v_pk_add_f32 v[74:75], v[74:75], v[158:159] neg_lo:[0,1] neg_hi:[0,1]
    v_pk_add_f32 v[76:77], v[76:77], v[156:157] neg_lo:[0,1] neg_hi:[0,1]
    v_pk_add_f32 v[78:79], v[78:79], v[158:159] neg_lo:[0,1] neg_hi:[0,1]
    v_pk_add_f32 v[80:81], v[80:81], v[156:157] neg_lo:[0,1] neg_hi:[0,1]
    v_pk_add_f32 v[82:83], v[82:83], v[158:159] neg_lo:[0,1] neg_hi:[0,1]
    v_pk_add_f32 v[84:85], v[84:85], v[156:157] neg_lo:[0,1] neg_hi:[0,1]
    v_pk_add_f32 v[86:87], v[86:87], v[158:159] neg_lo:[0,1] neg_hi:[0,1]
    v_pk_mul_f32 v[14:15], v[60:61], v[60:61]
    buffer_load_dwordx4 v28, s[24:27], s89 offen offset:1040 lds
    v_pk_mul_f32 v[16:17], v[62:63], v[62:63]
    v_pk_fma_f32 v[14:15], v[64:65], v[64:65], v[14:15]
    v_pk_fma_f32 v[16:17], v[66:67], v[66:67], v[16:17]
    v_pk_fma_f32 v[14:15], v[68:69], v[68:69], v[14:15]
    v_pk_fma_f32 v[16:17], v[70:71], v[70:71], v[16:17]
    v_pk_fma_f32 v[14:15], v[72:73], v[72:73], v[14:15]
    v_pk_fma_f32 v[16:17], v[74:75], v[74:75], v[16:17]
    v_pk_fma_f32 v[14:15], v[76:77], v[76:77], v[14:15]
    v_pk_fma_f32 v[16:17], v[78:79], v[78:79], v[16:17]
    v_pk_fma_f32 v[14:15], v[80:81], v[80:81], v[14:15]
    v_pk_fma_f32 v[16:17], v[82:83], v[82:83], v[16:17]
    v_pk_fma_f32 v[14:15], v[84:85], v[84:85], v[14:15]
    buffer_load_dwordx4 v29, s[24:27], s89 offen offset:2080 lds
    v_pk_fma_f32 v[16:17], v[86:87], v[86:87], v[16:17]
    v_add_f32_dpp v14, v14, v14 row_ror:8 row_mask:0xf bank_mask:0xf
    v_add_f32_dpp v15, v15, v15 row_ror:8 row_mask:0xf bank_mask:0xf
    v_add_f32_dpp v16, v16, v16 row_ror:8 row_mask:0xf bank_mask:0xf
    v_add_f32_dpp v17, v17, v17 row_ror:8 row_mask:0xf bank_mask:0xf
    v_add_f32_dpp v14, v14, v14 row_ror:4 row_mask:0xf bank_mask:0xf
    v_add_f32_dpp v15, v15, v15 row_ror:4 row_mask:0xf bank_mask:0xf
    v_add_f32_dpp v16, v16, v16 row_ror:4 row_mask:0xf bank_mask:0xf
    v_add_f32_dpp v17, v17, v17 row_ror:4 row_mask:0xf bank_mask:0xf
    v_add_f32_dpp v14, v14, v14 row_ror:2 row_mask:0xf bank_mask:0xf
    v_add_f32_dpp v15, v15, v15 row_ror:2 row_mask:0xf bank_mask:0xf
    v_add_f32_dpp v16, v16, v16 row_ror:2 row_mask:0xf bank_mask:0xf
    v_add_f32_dpp v17, v17, v17 row_ror:2 row_mask:0xf bank_mask:0xf
    v_add_f32_dpp v14, v14, v14 row_ror:1 row_mask:0xf bank_mask:0xf
    buffer_load_dwordx4 v2, s[24:27], s89 offen offset:3120 lds
    v_add_f32_dpp v15, v15, v15 row_ror:1 row_mask:0xf bank_mask:0xf
    v_add_f32_dpp v16, v16, v16 row_ror:1 row_mask:0xf bank_mask:0xf
    v_add_f32_dpp v17, v17, v17 row_ror:1 row_mask:0xf bank_mask:0xf
    v_cndmask_b32 v18, v156, v157, s[60:61]
    v_cndmask_b32 v19, v158, v159, s[60:61]
    v_cndmask_b32 v24, v18, v19, s[62:63]
    v_cndmask_b32 v18, v14, v15, s[60:61]
    v_cndmask_b32 v19, v16, v17, s[60:61]
    v_cndmask_b32 v26, v18, v19, s[62:63]
    v_mov_b32 v25, s56
    v_mov_b32 v27, s57
    s_lshl_b32 s77, s53, 10
    s_add_u32 s76, s81, s77
    s_mov_b64 exec, s[64:65]
    buffer_store_dwordx4 v[24:27], v160, s[36:39], s76 offen sc1
    s_mov_b64 exec, -1
    v_lshrrev_b32 v18, 2, v3
    v_lshl_add_u32 v160, v18, 10, v160
    v_add_u32 v161, 4096, v160
    s_lshl_b32 s76, s52, 2
    s_add_u32 s76, s76, s55
    s_lshl_b32 s76, s76, 1
    v_lshlrev_b32 v14, 8, v3
    buffer_load_ushort v5, v14, s[44:47], s76 offen
    s_waitcnt vmcnt(26)
    s_barrier
    v_add_u32 v220, 116592, v220
    v_add_u32 v221, 116592, v221
    v_add_u32 v222, 116592, v222
    v_add_u32 v223, 116592, v223
    ds_read_b64_tr_b16 v[172:173], v220 offset:0
    s_add_u32 m0, s6, 83280
    s_nop 0
    buffer_load_dwordx4 v8, s[20:23], s93 offen lds
    ds_read_b64_tr_b16 v[174:175], v220 offset:1024
    buffer_load_dwordx4 v9, s[20:23], s93 offen offset:1024 lds
    ds_read_b64_tr_b16 v[176:177], v221 offset:0
    ds_read_b64_tr_b16 v[178:179], v221 offset:1024
    ds_read_b64_tr_b16 v[180:181], v222 offset:0
    buffer_load_dwordx4 v13, s[20:23], s93 offen offset:2048 lds
    ds_read_b64_tr_b16 v[182:183], v222 offset:1024
    ds_read_b64_tr_b16 v[184:185], v223 offset:0
    ds_read_b64_tr_b16 v[186:187], v223 offset:1024
    ds_read_b64_tr_b16 v[188:189], v220 offset:2048
    ds_read_b64_tr_b16 v[190:191], v220 offset:3072
    ds_read_b64_tr_b16 v[192:193], v221 offset:2048
    ds_read_b64_tr_b16 v[194:195], v221 offset:3072
    ds_read_b64_tr_b16 v[196:197], v222 offset:2048
    buffer_load_dwordx4 v6, s[20:23], s93 offen offset:3072 lds
    ds_read_b64_tr_b16 v[198:199], v222 offset:3072
    ds_read_b64_tr_b16 v[200:201], v223 offset:2048
    ds_read_b64_tr_b16 v[202:203], v223 offset:3072
    s_waitcnt lgkmcnt(8)
    s_waitcnt vmcnt(26)
    s_barrier
    v_mfma_f32_16x16x32_bf16 v[32:35], v[172:175], a[192:195], 0
    ds_read_b64_tr_b16 v[204:205], v220 offset:16656
    ds_read_b64_tr_b16 v[206:207], v220 offset:17680
    s_waitcnt vmcnt(14)
    s_add_u32 m0, s6, 99936
    s_nop 0
    buffer_load_dwordx4 v8, s[20:23], s94 offen lds
    v_mfma_f32_16x16x32_bf16 v[56:59], v[172:175], a[128:131], 0
    ds_read_b64_tr_b16 v[208:209], v221 offset:16656
    ds_read_b64_tr_b16 v[210:211], v221 offset:17680
    ds_read_b64 a[0:1], v11 offset:0
    v_mfma_f32_16x16x32_bf16 v[36:39], v[176:179], a[192:195], 0
    ds_read_b64_tr_b16 v[212:213], v222 offset:16656
    ds_read_b64_tr_b16 v[214:215], v222 offset:17680
    ds_read_b64 a[2:3], v11 offset:256
    buffer_load_dwordx4 v9, s[20:23], s94 offen offset:1024 lds
    v_mfma_f32_16x16x32_bf16 v[52:55], v[176:179], a[128:131], 0
    ds_read_b64_tr_b16 v[216:217], v223 offset:16656
    ds_read_b64_tr_b16 v[218:219], v223 offset:17680
    ds_read_b64 a[4:5], v11 offset:16
    v_mfma_f32_16x16x32_bf16 v[40:43], v[180:183], a[192:195], 0
    ds_read_b64 a[6:7], v11 offset:272
    v_mfma_f32_16x16x32_bf16 v[48:51], v[180:183], a[128:131], 0
    ds_read_b64 a[8:9], v11 offset:32
    buffer_load_dwordx4 v13, s[20:23], s94 offen offset:2048 lds
    v_mfma_f32_16x16x32_bf16 v[44:47], v[184:187], a[192:195], 0
    ds_read_b64 a[10:11], v11 offset:288
    s_waitcnt lgkmcnt(14)
    v_mfma_f32_16x16x32_bf16 v[32:35], v[188:191], a[196:199], v[32:35]
    ds_read_b64_tr_b16 v[172:173], v220 offset:18704
    ds_read_b64_tr_b16 v[174:175], v220 offset:19728
    ds_read_b64 a[12:13], v11 offset:48
    buffer_load_dwordx4 v6, s[20:23], s94 offen offset:3072 lds
    v_mfma_f32_16x16x32_bf16 v[56:59], v[188:191], a[132:135], v[56:59]
    ds_read_b64_tr_b16 v[176:177], v221 offset:18704
    ds_read_b64_tr_b16 v[178:179], v221 offset:19728
    ds_read_b64 a[14:15], v11 offset:304
    v_mfma_f32_16x16x32_bf16 v[36:39], v[192:195], a[196:199], v[36:39]
    ds_read_b64_tr_b16 v[180:181], v222 offset:18704
    ds_read_b64_tr_b16 v[182:183], v222 offset:19728
    ds_read_b64 a[16:17], v11 offset:64
    v_mfma_f32_16x16x32_bf16 v[52:55], v[192:195], a[132:135], v[52:55]
    ds_read_b64_tr_b16 v[184:185], v223 offset:18704
    ds_read_b64_tr_b16 v[186:187], v223 offset:19728
    ds_read_b64 a[18:19], v11 offset:320
    v_mfma_f32_16x16x32_bf16 v[40:43], v[196:199], a[196:199], v[40:43]
    ds_read_b64 a[20:21], v11 offset:80
    v_mfma_f32_16x16x32_bf16 v[48:51], v[196:199], a[132:135], v[48:51]
    ds_read_b64 a[22:23], v11 offset:336
    v_mfma_f32_16x16x32_bf16 v[44:47], v[200:203], a[196:199], v[44:47]
    ds_read_b64 a[24:25], v11 offset:96
    s_waitcnt lgkmcnt(15)
    s_waitcnt vmcnt(26)
    s_barrier
    v_subrev_u32 v220, 49968, v220
    v_subrev_u32 v221, 49968, v221
    v_subrev_u32 v222, 49968, v222
    v_subrev_u32 v223, 49968, v223
    v_mfma_f32_16x16x32_bf16 v[32:35], v[204:207], a[200:203], v[32:35]
    ds_read_b64_tr_b16 v[188:189], v220 offset:0
    ds_read_b64_tr_b16 v[190:191], v220 offset:1024
    ds_read_b64 a[26:27], v11 offset:352
    s_add_u32 m0, s6, 116592
    s_nop 0
    buffer_load_dwordx4 v8, s[20:23], s95 offen lds
    v_mfma_f32_16x16x32_bf16 v[56:59], v[204:207], a[136:139], v[56:59]
    ds_read_b64_tr_b16 v[192:193], v221 offset:0
    ds_read_b64_tr_b16 v[194:195], v221 offset:1024
    ds_read_b64 a[28:29], v11 offset:112
    buffer_load_dwordx4 v9, s[20:23], s95 offen offset:1024 lds
    v_mfma_f32_16x16x32_bf16 v[36:39], v[208:211], a[200:203], v[36:39]
    ds_read_b64_tr_b16 v[196:197], v222 offset:0
    ds_read_b64_tr_b16 v[198:199], v222 offset:1024
    ds_read_b64 a[30:31], v11 offset:368
    buffer_load_dwordx4 v13, s[20:23], s95 offen offset:2048 lds
    v_mfma_f32_16x16x32_bf16 v[52:55], v[208:211], a[136:139], v[52:55]
    ds_read_b64_tr_b16 v[200:201], v223 offset:0
    ds_read_b64_tr_b16 v[202:203], v223 offset:1024
    s_waitcnt vmcnt(13)
    buffer_load_dwordx4 v6, s[20:23], s95 offen offset:3072 lds
    v_mfma_f32_16x16x32_bf16 v[40:43], v[212:215], a[200:203], v[40:43]
    ds_read_b64 a[32:33], v11 offset:8320
    v_mfma_f32_16x16x32_bf16 v[48:51], v[212:215], a[136:139], v[48:51]
    ds_read_b64 a[34:35], v11 offset:8576
    v_mfma_f32_16x16x32_bf16 v[44:47], v[216:219], a[200:203], v[44:47]
    ds_read_b64 a[36:37], v11 offset:8336
    s_waitcnt lgkmcnt(15)
    v_mfma_f32_16x16x32_bf16 v[32:35], v[172:175], a[204:207], v[32:35]
    ds_read_b64_tr_b16 v[204:205], v220 offset:2048
    ds_read_b64_tr_b16 v[206:207], v220 offset:3072
    ds_read_b64 a[38:39], v11 offset:8592
    v_mfma_f32_16x16x32_bf16 v[56:59], v[172:175], a[140:143], v[56:59]
    ds_read_b64_tr_b16 v[208:209], v221 offset:2048
    ds_read_b64_tr_b16 v[210:211], v221 offset:3072
    ds_read_b64 a[40:41], v11 offset:8352
    v_mfma_f32_16x16x32_bf16 v[36:39], v[176:179], a[204:207], v[36:39]
    ds_read_b64_tr_b16 v[212:213], v222 offset:2048
    ds_read_b64_tr_b16 v[214:215], v222 offset:3072
    ds_read_b64 a[42:43], v11 offset:8608
    v_mfma_f32_16x16x32_bf16 v[52:55], v[176:179], a[140:143], v[52:55]
    ds_read_b64_tr_b16 v[216:217], v223 offset:2048
    ds_read_b64_tr_b16 v[218:219], v223 offset:3072
    ds_read_b64 a[44:45], v11 offset:8368
    v_mfma_f32_16x16x32_bf16 v[40:43], v[180:183], a[204:207], v[40:43]
    ds_read_b64 a[46:47], v11 offset:8624
    v_mfma_f32_16x16x32_bf16 v[48:51], v[180:183], a[140:143], v[48:51]
    ds_read_b64 a[48:49], v11 offset:8384
    v_mfma_f32_16x16x32_bf16 v[44:47], v[184:187], a[204:207], v[44:47]
    ds_read_b64 a[50:51], v11 offset:8640
    s_waitcnt lgkmcnt(15)
    s_waitcnt vmcnt(8)
    s_barrier
    v_mfma_f32_16x16x32_bf16 v[32:35], v[188:191], a[208:211], v[32:35]
    ds_read_b64_tr_b16 v[172:173], v220 offset:16656
    ds_read_b64_tr_b16 v[174:175], v220 offset:17680
    ds_read_b64 a[52:53], v11 offset:8400
    s_add_u32 m0, s6, 133248
    s_nop 0
    buffer_load_dwordx4 v8, s[20:23], s96 offen lds
    v_mfma_f32_16x16x32_bf16 v[56:59], v[188:191], a[144:147], v[56:59]
    ds_read_b64_tr_b16 v[176:177], v221 offset:16656
    ds_read_b64_tr_b16 v[178:179], v221 offset:17680
    ds_read_b64 a[54:55], v11 offset:8656
    buffer_load_dwordx4 v9, s[20:23], s96 offen offset:1024 lds
    v_mfma_f32_16x16x32_bf16 v[36:39], v[192:195], a[208:211], v[36:39]
    ds_read_b64_tr_b16 v[180:181], v222 offset:16656
    ds_read_b64_tr_b16 v[182:183], v222 offset:17680
    ds_read_b64 a[56:57], v11 offset:8416
    buffer_load_dwordx4 v13, s[20:23], s96 offen offset:2048 lds
    v_mfma_f32_16x16x32_bf16 v[52:55], v[192:195], a[144:147], v[52:55]
    ds_read_b64_tr_b16 v[184:185], v223 offset:16656
    ds_read_b64_tr_b16 v[186:187], v223 offset:17680
    ds_read_b64 a[58:59], v11 offset:8672
    buffer_load_dwordx4 v6, s[20:23], s96 offen offset:3072 lds
    v_mfma_f32_16x16x32_bf16 v[40:43], v[196:199], a[208:211], v[40:43]
    ds_read_b64 a[60:61], v11 offset:8432
    s_xor_b32 s89, s72, 4096
    s_add_u32 m0, s73, 0
    s_nop 0
    buffer_load_dwordx4 v10, s[24:27], s89 offen lds
    v_mfma_f32_16x16x32_bf16 v[48:51], v[196:199], a[144:147], v[48:51]
    ds_read_b64 a[62:63], v11 offset:8688
    buffer_load_dwordx4 v28, s[24:27], s89 offen offset:1040 lds
    v_mfma_f32_16x16x32_bf16 v[44:47], v[200:203], a[208:211], v[44:47]
    buffer_load_dwordx4 v29, s[24:27], s89 offen offset:2080 lds
    s_waitcnt lgkmcnt(15)
    v_mfma_f32_16x16x32_bf16 v[32:35], v[204:207], a[212:215], v[32:35]
    ds_read_b64_tr_b16 v[188:189], v220 offset:18704
    ds_read_b64_tr_b16 v[190:191], v220 offset:19728
    v_mfma_f32_16x16x32_bf16 v[56:59], v[204:207], a[148:151], v[56:59]
    ds_read_b64_tr_b16 v[192:193], v221 offset:18704
    ds_read_b64_tr_b16 v[194:195], v221 offset:19728
    v_mfma_f32_16x16x32_bf16 v[36:39], v[208:211], a[212:215], v[36:39]
    ds_read_b64_tr_b16 v[196:197], v222 offset:18704
    ds_read_b64_tr_b16 v[198:199], v222 offset:19728
    buffer_load_dwordx4 v2, s[24:27], s89 offen offset:3120 lds
    v_mfma_f32_16x16x32_bf16 v[52:55], v[208:211], a[148:151], v[52:55]
    ds_read_b64_tr_b16 v[200:201], v223 offset:18704
    ds_read_b64_tr_b16 v[202:203], v223 offset:19728
    v_mfma_f32_16x16x32_bf16 v[40:43], v[212:215], a[212:215], v[40:43]
    v_mfma_f32_16x16x32_bf16 v[48:51], v[212:215], a[148:151], v[48:51]
    s_xor_b32 s89, s89, 4194304
    s_add_u32 m0, s74, 0
    s_nop 0
    buffer_load_dwordx4 v10, s[24:27], s89 offen lds
    v_mfma_f32_16x16x32_bf16 v[44:47], v[216:219], a[212:215], v[44:47]
    s_waitcnt lgkmcnt(11)
    s_waitcnt vmcnt(13)
    s_barrier
    v_mfma_f32_16x16x32_bf16 v[32:35], v[172:175], a[216:219], v[32:35]
    ds_read_b64_tr_b16 v[204:205], v220 offset:33312
    ds_read_b64_tr_b16 v[206:207], v220 offset:34336
    buffer_load_dwordx4 v28, s[24:27], s89 offen offset:1040 lds
    v_mfma_f32_16x16x32_bf16 v[56:59], v[172:175], a[152:155], v[56:59]
    ds_read_b64_tr_b16 v[208:209], v221 offset:33312
    ds_read_b64_tr_b16 v[210:211], v221 offset:34336
    v_mfma_f32_16x16x32_bf16 v[36:39], v[176:179], a[216:219], v[36:39]
    ds_read_b64_tr_b16 v[212:213], v222 offset:33312
    ds_read_b64_tr_b16 v[214:215], v222 offset:34336
    buffer_load_dwordx4 v29, s[24:27], s89 offen offset:2080 lds
    v_mfma_f32_16x16x32_bf16 v[52:55], v[176:179], a[152:155], v[52:55]
    ds_read_b64_tr_b16 v[216:217], v223 offset:33312
    ds_read_b64_tr_b16 v[218:219], v223 offset:34336
    v_mfma_f32_16x16x32_bf16 v[40:43], v[180:183], a[216:219], v[40:43]
    v_mfma_f32_16x16x32_bf16 v[48:51], v[180:183], a[152:155], v[48:51]
    v_mfma_f32_16x16x32_bf16 v[44:47], v[184:187], a[216:219], v[44:47]
    buffer_load_dwordx4 v2, s[24:27], s89 offen offset:3120 lds
    s_waitcnt lgkmcnt(8)
    v_mfma_f32_16x16x32_bf16 v[32:35], v[188:191], a[220:223], v[32:35]
    ds_read_b64_tr_b16 v[172:173], v220 offset:35360
    ds_read_b64_tr_b16 v[174:175], v220 offset:36384
    v_mfma_f32_16x16x32_bf16 v[56:59], v[188:191], a[156:159], v[56:59]
    ds_read_b64_tr_b16 v[176:177], v221 offset:35360
    ds_read_b64_tr_b16 v[178:179], v221 offset:36384
    v_mfma_f32_16x16x32_bf16 v[36:39], v[192:195], a[220:223], v[36:39]
    ds_read_b64_tr_b16 v[180:181], v222 offset:35360
    ds_read_b64_tr_b16 v[182:183], v222 offset:36384
    s_add_u32 m0, s6, 66624
    s_nop 0
    buffer_load_dwordx4 v8, s[20:23], s97 offen lds
    v_mfma_f32_16x16x32_bf16 v[52:55], v[192:195], a[156:159], v[52:55]
    ds_read_b64_tr_b16 v[184:185], v223 offset:35360
    ds_read_b64_tr_b16 v[186:187], v223 offset:36384
    v_mfma_f32_16x16x32_bf16 v[40:43], v[196:199], a[220:223], v[40:43]
    v_mfma_f32_16x16x32_bf16 v[48:51], v[196:199], a[156:159], v[48:51]
    v_mfma_f32_16x16x32_bf16 v[44:47], v[200:203], a[220:223], v[44:47]
    buffer_load_dwordx4 v9, s[20:23], s97 offen offset:1024 lds
    s_waitcnt lgkmcnt(8)
    s_waitcnt vmcnt(14)
    s_barrier
    buffer_load_dwordx4 v[164:167], v160, s[36:39], s81 offen sc1
    buffer_load_dwordx4 v[168:171], v161, s[36:39], s81 offen sc1
    v_add_u32 v220, 49968, v220
    v_add_u32 v221, 49968, v221
    v_add_u32 v222, 49968, v222
    v_add_u32 v223, 49968, v223
    v_mfma_f32_16x16x32_bf16 v[32:35], v[204:207], a[224:227], v[32:35]
    ds_read_b64_tr_b16 v[188:189], v220 offset:0
    ds_read_b64_tr_b16 v[190:191], v220 offset:1024
    buffer_load_dwordx4 v13, s[20:23], s97 offen offset:2048 lds
    v_mfma_f32_16x16x32_bf16 v[56:59], v[204:207], a[160:163], v[56:59]
    ds_read_b64_tr_b16 v[192:193], v221 offset:0
    ds_read_b64_tr_b16 v[194:195], v221 offset:1024
    v_mfma_f32_16x16x32_bf16 v[36:39], v[208:211], a[224:227], v[36:39]
    ds_read_b64_tr_b16 v[196:197], v222 offset:0
    ds_read_b64_tr_b16 v[198:199], v222 offset:1024
    buffer_load_dwordx4 v6, s[20:23], s97 offen offset:3072 lds
    v_mfma_f32_16x16x32_bf16 v[52:55], v[208:211], a[160:163], v[52:55]
    ds_read_b64_tr_b16 v[200:201], v223 offset:0
    ds_read_b64_tr_b16 v[202:203], v223 offset:1024
    v_mfma_f32_16x16x32_bf16 v[40:43], v[212:215], a[224:227], v[40:43]
    v_mfma_f32_16x16x32_bf16 v[48:51], v[212:215], a[160:163], v[48:51]
    v_mfma_f32_16x16x32_bf16 v[44:47], v[216:219], a[224:227], v[44:47]
    s_waitcnt lgkmcnt(8)
    v_mfma_f32_16x16x32_bf16 v[32:35], v[172:175], a[228:231], v[32:35]
    ds_read_b64_tr_b16 v[204:205], v220 offset:2048
    ds_read_b64_tr_b16 v[206:207], v220 offset:3072
    s_add_u32 s87, s7, 0
    s_mul_i32 s88, s54, 4160
    s_add_u32 m0, s88, 83280
    s_nop 0
    global_load_lds_dwordx4 v[238:239], off
    v_mfma_f32_16x16x32_bf16 v[56:59], v[172:175], a[164:167], v[56:59]
    ds_read_b64_tr_b16 v[208:209], v221 offset:2048
    ds_read_b64_tr_b16 v[210:211], v221 offset:3072
    buffer_load_dwordx4 v227, s[12:15], s87 offen offset:1040 lds
    v_mfma_f32_16x16x32_bf16 v[36:39], v[176:179], a[228:231], v[36:39]
    ds_read_b64_tr_b16 v[212:213], v222 offset:2048
    ds_read_b64_tr_b16 v[214:215], v222 offset:3072
    v_mfma_f32_16x16x32_bf16 v[52:55], v[176:179], a[164:167], v[52:55]
    ds_read_b64_tr_b16 v[216:217], v223 offset:2048
    ds_read_b64_tr_b16 v[218:219], v223 offset:3072
    v_mfma_f32_16x16x32_bf16 v[40:43], v[180:183], a[228:231], v[40:43]
    buffer_load_dwordx4 v229, s[12:15], s87 offen offset:3120 lds
    v_mfma_f32_16x16x32_bf16 v[48:51], v[180:183], a[164:167], v[48:51]
    v_mfma_f32_16x16x32_bf16 v[44:47], v[184:187], a[228:231], v[44:47]
    s_waitcnt lgkmcnt(8)
    s_waitcnt vmcnt(17)
    s_barrier
    v_mfma_f32_16x16x32_bf16 v[32:35], v[188:191], a[232:235], v[32:35]
    ds_read_b64_tr_b16 v[172:173], v220 offset:16656
    ds_read_b64_tr_b16 v[174:175], v220 offset:17680
    s_add_u32 m0, m0, 32
    s_nop 0
    global_load_lds_dwordx4 v[238:239], off offset:2048
    v_mfma_f32_16x16x32_bf16 v[56:59], v[188:191], a[168:171], v[56:59]
    ds_read_b64_tr_b16 v[176:177], v221 offset:16656
    ds_read_b64_tr_b16 v[178:179], v221 offset:17680
    s_add_u32 s87, s7, 16384
    s_mul_i32 s88, s54, 4160
    s_add_u32 m0, s88, 99936
    v_add_co_u32 v238, s[48:49], s50, v238
    s_nop 1
    v_addc_co_u32 v239, s[48:49], 0, v239, s[48:49]
    global_load_lds_dwordx4 v[238:239], off
    v_mfma_f32_16x16x32_bf16 v[36:39], v[192:195], a[232:235], v[36:39]
    ds_read_b64_tr_b16 v[180:181], v222 offset:16656
    ds_read_b64_tr_b16 v[182:183], v222 offset:17680
    v_mfma_f32_16x16x32_bf16 v[52:55], v[192:195], a[168:171], v[52:55]
    ds_read_b64_tr_b16 v[184:185], v223 offset:16656
    ds_read_b64_tr_b16 v[186:187], v223 offset:17680
    buffer_load_dwordx4 v227, s[12:15], s87 offen offset:1040 lds
    v_mfma_f32_16x16x32_bf16 v[40:43], v[196:199], a[232:235], v[40:43]
    v_mfma_f32_16x16x32_bf16 v[48:51], v[196:199], a[168:171], v[48:51]
    v_mfma_f32_16x16x32_bf16 v[44:47], v[200:203], a[232:235], v[44:47]
    buffer_load_dwordx4 v229, s[12:15], s87 offen offset:3120 lds
    s_waitcnt lgkmcnt(8)
    v_mfma_f32_16x16x32_bf16 v[32:35], v[204:207], a[236:239], v[32:35]
    ds_read_b64_tr_b16 v[188:189], v220 offset:18704
    ds_read_b64_tr_b16 v[190:191], v220 offset:19728
    v_mfma_f32_16x16x32_bf16 v[56:59], v[204:207], a[172:175], v[56:59]
    ds_read_b64_tr_b16 v[192:193], v221 offset:18704
    ds_read_b64_tr_b16 v[194:195], v221 offset:19728
    v_mfma_f32_16x16x32_bf16 v[36:39], v[208:211], a[236:239], v[36:39]
    ds_read_b64_tr_b16 v[196:197], v222 offset:18704
    ds_read_b64_tr_b16 v[198:199], v222 offset:19728
    s_add_u32 m0, m0, 32
    s_nop 0
    global_load_lds_dwordx4 v[238:239], off offset:2048
    v_mfma_f32_16x16x32_bf16 v[52:55], v[208:211], a[172:175], v[52:55]
    ds_read_b64_tr_b16 v[200:201], v223 offset:18704
    ds_read_b64_tr_b16 v[202:203], v223 offset:19728
    v_mfma_f32_16x16x32_bf16 v[40:43], v[212:215], a[236:239], v[40:43]
    s_xor_b32 s89, s72, 4224
    s_add_u32 m0, s73, 8320
    s_nop 0
    buffer_load_dwordx4 v10, s[24:27], s89 offen lds
    v_mfma_f32_16x16x32_bf16 v[48:51], v[212:215], a[172:175], v[48:51]
    v_mfma_f32_16x16x32_bf16 v[44:47], v[216:219], a[236:239], v[44:47]
    s_waitcnt vmcnt(11)
    s_mov_b32 s82, 0
L_stat:
    v_xor_b32 v24, s56, v165
    v_xor_b32 v25, s57, v167
    v_xor_b32 v26, s56, v169
    v_xor_b32 v27, s57, v171
    v_or3_b32 v24, v24, v25, v26
    v_or_b32 v24, v24, v27
    v_cmp_ne_u32 vcc, 0, v24
    s_cbranch_vccz L_statok
    s_add_u32 s82, s82, 1
    s_cmp_ge_u32 s82, 200000
    s_cbranch_scc1 L_statok
    buffer_load_dwordx4 v[164:167], v160, s[36:39], s81 offen sc1
    buffer_load_dwordx4 v[168:171], v161, s[36:39], s81 offen sc1
    s_waitcnt vmcnt(0)
    s_branch L_stat
L_statok:
    v_add_f32 v24, v164, v168
    s_waitcnt vmcnt(15)
    buffer_load_dwordx4 v28, s[24:27], s89 offen offset:1040 lds
    v_add_f32_dpp v24, v24, v24 row_ror:4 row_mask:0xf bank_mask:0xf
    ds_read_b64 a[64:65], v11 offset:0
    s_nop 0
    v_add_f32_dpp v24, v24, v24 row_ror:8 row_mask:0xf bank_mask:0xf
    ds_read_b64 a[66:67], v11 offset:256
    buffer_load_dwordx4 v29, s[24:27], s89 offen offset:2080 lds
    v_mul_f32 v24, 0x3e000000, v24
    ds_read_b64 a[68:69], v11 offset:16
    v_sub_f32 v16, v164, v24
    ds_read_b64 a[70:71], v11 offset:272
    v_sub_f32 v20, v168, v24
    ds_read_b64 a[72:73], v11 offset:32
    v_mul_f32 v16, v16, v16
    ds_read_b64 a[74:75], v11 offset:288
    v_fmac_f32 v16, v20, v20
    ds_read_b64 a[76:77], v11 offset:48
    buffer_load_dwordx4 v2, s[24:27], s89 offen offset:3120 lds
    v_add_f32 v17, v166, v170
    ds_read_b64 a[78:79], v11 offset:304
    v_fmac_f32 v17, 0x42e00000, v16
    ds_read_b64 a[80:81], v11 offset:64
    s_nop 0
    v_add_f32_dpp v17, v17, v17 row_ror:4 row_mask:0xf bank_mask:0xf
    ds_read_b64 a[82:83], v11 offset:320
    s_nop 0
    v_add_f32_dpp v17, v17, v17 row_ror:8 row_mask:0xf bank_mask:0xf
    ds_read_b64 a[84:85], v11 offset:80
    s_xor_b32 s89, s89, 4194304
    s_add_u32 m0, s74, 8320
    s_nop 0
    buffer_load_dwordx4 v10, s[24:27], s89 offen lds
    v_mov_b32 v18, 0x3727c5ac
    ds_read_b64 a[86:87], v11 offset:336
    v_fmac_f32 v18, 0x3a924925, v17
    ds_read_b64 a[88:89], v11 offset:96
    v_rsq_f32 v25, v18
    ds_read_b64 a[90:91], v11 offset:352
    v_mov_b32_dpp v18, v24 quad_perm:[0,0,0,0] row_mask:0xf bank_mask:0xf
    ds_read_b64 a[92:93], v11 offset:112
    buffer_load_dwordx4 v28, s[24:27], s89 offen offset:1040 lds
    v_mov_b32_dpp v19, v24 quad_perm:[1,1,1,1] row_mask:0xf bank_mask:0xf
    ds_read_b64 a[94:95], v11 offset:368
    v_mov_b32_dpp v20, v24 quad_perm:[2,2,2,2] row_mask:0xf bank_mask:0xf
    v_mov_b32_dpp v21, v24 quad_perm:[3,3,3,3] row_mask:0xf bank_mask:0xf
    v_mov_b32_dpp v14, v25 quad_perm:[0,0,0,0] row_mask:0xf bank_mask:0xf
    v_mov_b32_dpp v15, v25 quad_perm:[1,1,1,1] row_mask:0xf bank_mask:0xf
    v_mov_b32_dpp v16, v25 quad_perm:[2,2,2,2] row_mask:0xf bank_mask:0xf
    v_mov_b32_dpp v17, v25 quad_perm:[3,3,3,3] row_mask:0xf bank_mask:0xf
    v_pk_add_f32 v[18:19], v[156:157], v[18:19] neg_lo:[0,1] neg_hi:[0,1]
    v_pk_add_f32 v[20:21], v[158:159], v[20:21] neg_lo:[0,1] neg_hi:[0,1]
    v_pk_mul_f32 v[18:19], v[18:19], v[14:15]
    v_pk_mul_f32 v[20:21], v[20:21], v[16:17]
    buffer_load_dwordx4 v29, s[24:27], s89 offen offset:2080 lds
    v_pk_fma_f32 v[60:61], v[60:61], v[14:15], v[18:19]
    v_pk_fma_f32 v[62:63], v[62:63], v[16:17], v[20:21]
    v_pk_fma_f32 v[64:65], v[64:65], v[14:15], v[18:19]
    v_pk_fma_f32 v[66:67], v[66:67], v[16:17], v[20:21]
    v_pk_fma_f32 v[68:69], v[68:69], v[14:15], v[18:19]
    v_pk_fma_f32 v[70:71], v[70:71], v[16:17], v[20:21]
    v_pk_fma_f32 v[72:73], v[72:73], v[14:15], v[18:19]
    v_pk_fma_f32 v[74:75], v[74:75], v[16:17], v[20:21]
    v_pk_fma_f32 v[76:77], v[76:77], v[14:15], v[18:19]
    v_pk_fma_f32 v[78:79], v[78:79], v[16:17], v[20:21]
    s_waitcnt lgkmcnt(0)
    v_pk_fma_f32 v[80:81], v[80:81], v[14:15], v[18:19]
    buffer_load_dwordx4 v2, s[24:27], s89 offen offset:3120 lds
    v_pk_fma_f32 v[82:83], v[82:83], v[16:17], v[20:21]
    v_pk_fma_f32 v[84:85], v[84:85], v[14:15], v[18:19]
    v_pk_fma_f32 v[86:87], v[86:87], v[16:17], v[20:21]
    v_cvt_pk_bf16_f32 v108, v60, v61
    v_cvt_pk_bf16_f32 v109, v62, v63
    v_cvt_pk_bf16_f32 v110, v64, v65
    v_cvt_pk_bf16_f32 v111, v66, v67
    v_cvt_pk_bf16_f32 v112, v68, v69
    v_cvt_pk_bf16_f32 v113, v70, v71
    v_cvt_pk_bf16_f32 v114, v72, v73
    v_cvt_pk_bf16_f32 v115, v74, v75
    v_cvt_pk_bf16_f32 v116, v76, v77
    v_cvt_pk_bf16_f32 v117, v78, v79
    s_xor_b32 s89, s72, 8192
    s_add_u32 m0, s73, 0
    s_nop 0
    buffer_load_dwordx4 v10, s[24:27], s89 offen lds
    v_cvt_pk_bf16_f32 v118, v80, v81
    v_cvt_pk_bf16_f32 v119, v82, v83
    v_cvt_pk_bf16_f32 v120, v84, v85
    v_cvt_pk_bf16_f32 v121, v86, v87
    v_mov_b32 v122, v120
    v_mov_b32 v123, v121
    v_permlane32_swap_b32 v108, v110
    v_permlane32_swap_b32 v109, v111
    v_permlane32_swap_b32 v112, v114
    v_permlane32_swap_b32 v113, v115
    v_permlane32_swap_b32 v116, v118
    v_permlane32_swap_b32 v117, v119
    buffer_load_dwordx4 v28, s[24:27], s89 offen offset:1040 lds
    v_permlane32_swap_b32 v120, v122
    v_permlane32_swap_b32 v121, v123
    buffer_store_dwordx4 v[108:111], v12, s[36:39], s84 offen sc1
    s_add_u32 s84, s84, 32768
    buffer_store_dwordx4 v[112:115], v12, s[36:39], s84 offen sc1
    s_add_u32 s84, s84, 32768
    buffer_store_dwordx4 v[116:119], v12, s[36:39], s84 offen sc1
    s_add_u32 s84, s84, 32768
    s_mov_b64 exec, s[66:67]
    buffer_store_dwordx4 v[120:123], v12, s[36:39], s84 offen sc1
    s_mov_b64 exec, -1
    s_waitcnt vmcnt(22)
    s_barrier
    v_subrev_u32 v220, 49968, v220
    v_subrev_u32 v221, 49968, v221
    v_subrev_u32 v222, 49968, v222
    v_subrev_u32 v223, 49968, v223
    v_mfma_f32_16x16x32_bf16 v[32:35], v[172:175], a[240:243], v[32:35]
    ds_read_b64_tr_b16 v[204:205], v220 offset:0
    ds_read_b64_tr_b16 v[206:207], v220 offset:1024
    buffer_load_dwordx4 v29, s[24:27], s89 offen offset:2080 lds
    v_mfma_f32_16x16x32_bf16 v[56:59], v[172:175], a[176:179], v[56:59]
    ds_read_b64_tr_b16 v[208:209], v221 offset:0
    ds_read_b64_tr_b16 v[210:211], v221 offset:1024
    buffer_load_dwordx4 v2, s[24:27], s89 offen offset:3120 lds
    v_mfma_f32_16x16x32_bf16 v[36:39], v[176:179], a[240:243], v[36:39]
    ds_read_b64_tr_b16 v[212:213], v222 offset:0
    ds_read_b64_tr_b16 v[214:215], v222 offset:1024
    v_mfma_f32_16x16x32_bf16 v[52:55], v[176:179], a[176:179], v[52:55]
    ds_read_b64_tr_b16 v[216:217], v223 offset:0
    ds_read_b64_tr_b16 v[218:219], v223 offset:1024
    s_xor_b32 s89, s89, 4194304
    s_add_u32 m0, s74, 0
    s_nop 0
    buffer_load_dwordx4 v10, s[24:27], s89 offen lds
    v_mfma_f32_16x16x32_bf16 v[40:43], v[180:183], a[240:243], v[40:43]
    v_mfma_f32_16x16x32_bf16 v[48:51], v[180:183], a[176:179], v[48:51]
    v_mfma_f32_16x16x32_bf16 v[44:47], v[184:187], a[240:243], v[44:47]
    buffer_load_dwordx4 v28, s[24:27], s89 offen offset:1040 lds
    v_mfma_f32_16x16x32_bf16 v[32:35], v[188:191], a[244:247], v[32:35]
    ds_read_b64_tr_b16 v[172:173], v220 offset:2048
    ds_read_b64_tr_b16 v[174:175], v220 offset:3072
    v_mfma_f32_16x16x32_bf16 v[56:59], v[188:191], a[180:183], v[56:59]
    ds_read_b64_tr_b16 v[176:177], v221 offset:2048
    ds_read_b64_tr_b16 v[178:179], v221 offset:3072
    v_mfma_f32_16x16x32_bf16 v[36:39], v[192:195], a[244:247], v[36:39]
    ds_read_b64_tr_b16 v[180:181], v222 offset:2048
    ds_read_b64_tr_b16 v[182:183], v222 offset:3072
    buffer_load_dwordx4 v29, s[24:27], s89 offen offset:2080 lds
    v_mfma_f32_16x16x32_bf16 v[52:55], v[192:195], a[180:183], v[52:55]
    ds_read_b64_tr_b16 v[184:185], v223 offset:2048
    ds_read_b64_tr_b16 v[186:187], v223 offset:3072
    v_mfma_f32_16x16x32_bf16 v[40:43], v[196:199], a[244:247], v[40:43]
    v_mfma_f32_16x16x32_bf16 v[48:51], v[196:199], a[180:183], v[48:51]
    v_mfma_f32_16x16x32_bf16 v[44:47], v[200:203], a[244:247], v[44:47]
    buffer_load_dwordx4 v2, s[24:27], s89 offen offset:3120 lds
    s_waitcnt lgkmcnt(8)
    s_waitcnt vmcnt(24)
    s_or_b32 s76, s54, s53
    s_cbranch_scc1 L_nopatch
    v_mov_b32 v168, 0xbf803f80
    v_mov_b32 v169, v168
    v_mov_b32 v170, v168
    v_mov_b32 v171, v168
    v_add_u32 v167, 83792, v1
    s_mov_b64 exec, s[66:67]
    ds_write_b128 v167, v[168:171]
    s_mov_b64 exec, -1
    s_waitcnt lgkmcnt(0)
L_nopatch:
    s_barrier
    v_add_u32 v225, 66624, v225
    v_add_u32 v236, 66624, v236
    v_mfma_f32_16x16x32_bf16 v[32:35], v[204:207], a[248:251], v[32:35]
    ds_read_b128 v[60:63], v225 offset:16656
    v_mfma_f32_16x16x32_bf16 v[56:59], v[204:207], a[184:187], v[56:59]
    ds_read_b128 v[64:67], v236 offset:16656
    v_mfma_f32_16x16x32_bf16 v[36:39], v[208:211], a[248:251], v[36:39]
    ds_read_b128 v[68:71], v225 offset:16672
    v_mfma_f32_16x16x32_bf16 v[52:55], v[208:211], a[184:187], v[52:55]
    ds_read_b128 v[72:75], v236 offset:16672
    v_mfma_f32_16x16x32_bf16 v[40:43], v[212:215], a[248:251], v[40:43]
    ds_read_b128 v[76:79], v224 offset:0
    v_mfma_f32_16x16x32_bf16 v[48:51], v[212:215], a[184:187], v[48:51]
    v_mfma_f32_16x16x32_bf16 v[44:47], v[216:219], a[248:251], v[44:47]
    s_waitcnt lgkmcnt(5)
    v_mfma_f32_16x16x32_bf16 v[32:35], v[172:175], a[252:255], v[32:35]
    ds_read_b128 v[192:195], v225 offset:16688
    v_mfma_f32_16x16x32_bf16 v[56:59], v[172:175], a[188:191], v[56:59]
    ds_read_b128 v[196:199], v236 offset:16688
    v_mfma_f32_16x16x32_bf16 v[36:39], v[176:179], a[252:255], v[36:39]
    ds_read_b128 v[200:203], v225 offset:16704
    v_mfma_f32_16x16x32_bf16 v[52:55], v[176:179], a[188:191], v[52:55]
    ds_read_b128 v[204:207], v236 offset:16704
    v_mfma_f32_16x16x32_bf16 v[40:43], v[180:183], a[252:255], v[40:43]
    ds_read_b128 v[208:211], v224 offset:16
    v_mfma_f32_16x16x32_bf16 v[48:51], v[180:183], a[188:191], v[48:51]
    v_mfma_f32_16x16x32_bf16 v[44:47], v[184:187], a[252:255], v[44:47]
    s_waitcnt vmcnt(6)
    s_lshl_b32 s76, s52, 3
    s_add_u32 s76, s76, s75
    s_xor_b32 s76, s76, 1024
    v_mov_b32 v168, s56
    v_mov_b32 v169, s57
    s_mov_b64 exec, 1
    buffer_store_dwordx2 v[168:169], off, s[36:39], s76 sc1
    s_mov_b64 exec, -1
    ds_write_b128 v230, v[48:51] offset:0
    ds_write_b128 v230, v[52:55] offset:1024
    ds_write_b128 v230, v[56:59] offset:2048
    s_waitcnt lgkmcnt(0)
    v_lshrrev_b32 v14, 3, v0
    v_lshlrev_b32 v15, 10, v14
    v_and_b32 v14, 7, v0
    v_lshlrev_b32 v16, 1, v4
    v_xor_b32 v14, v14, v16
    v_lshl_add_u32 v9, v14, 4, v15
    v_add_u32 v13, 7168, v9
    v_add_u32 v26, 7168, v13
    v_add_u32 v27, 7168, v26
    s_lshr_b32 s76, s54, 1
    s_mul_i32 s76, s76, 458752
    s_lshl_b32 s77, s53, 7
    s_add_u32 s76, s76, s77
    s_and_b32 s77, s54, 1
    s_mul_i32 s77, s77, 114688
    s_add_u32 s96, s76, s77
    s_add_u32 s97, s96, s77
    v_mfma_f32_16x16x32_bf16 v[88:91], a[192:195], v[60:63], 0
    ds_read_b128 v[172:175], v225 offset:16720
    s_waitcnt vmcnt(13)
    s_add_u32 m0, s6, 116592
    s_add_u32 s87, s96, 0
    buffer_load_dwordx4 v9, s[28:31], s87 offen lds
    v_mfma_f32_16x16x32_bf16 v[96:99], a[192:195], v[64:67], 0
    ds_read_b128 v[176:179], v236 offset:16720
    ds_read_b64 a[96:97], v11 offset:8320
    buffer_load_dwordx4 v13, s[28:31], s87 offen offset:1024 lds
    v_mfma_f32_16x16x32_bf16 v[104:107], v[76:79], a[192:195], 0
    ds_read_b128 v[180:183], v225 offset:16736
    ds_read_b64 a[98:99], v11 offset:8576
    buffer_load_dwordx4 v26, s[28:31], s87 offen offset:2048 lds
    v_mfma_f32_16x16x32_bf16 v[88:91], a[196:199], v[68:71], v[88:91]
    ds_read_b128 v[184:187], v236 offset:16736
    ds_read_b64 a[100:101], v11 offset:8336
    buffer_load_dwordx4 v27, s[28:31], s87 offen offset:3072 lds
    v_mfma_f32_16x16x32_bf16 v[96:99], a[196:199], v[72:75], v[96:99]
    ds_read_b128 v[188:191], v224 offset:32
    ds_read_b64 a[102:103], v11 offset:8592
    s_add_u32 m0, s6, 133248
    s_add_u32 s87, s96, 229376
    buffer_load_dwordx4 v9, s[28:31], s87 offen lds
    v_mfma_f32_16x16x32_bf16 v[88:91], a[200:203], v[192:195], v[88:91]
    ds_read_b128 v[60:63], v225 offset:16752
    ds_read_b64 a[104:105], v11 offset:8352
    buffer_load_dwordx4 v13, s[28:31], s87 offen offset:1024 lds
    v_mfma_f32_16x16x32_bf16 v[96:99], a[200:203], v[196:199], v[96:99]
    ds_read_b128 v[64:67], v236 offset:16752
    ds_read_b64 a[106:107], v11 offset:8608
    buffer_load_dwordx4 v26, s[28:31], s87 offen offset:2048 lds
    v_mfma_f32_16x16x32_bf16 v[104:107], v[208:211], a[196:199], v[104:107]
    ds_read_b128 v[68:71], v225 offset:16768
    ds_read_b64 a[108:109], v11 offset:8368
    buffer_load_dwordx4 v27, s[28:31], s87 offen offset:3072 lds
    v_mfma_f32_16x16x32_bf16 v[88:91], a[204:207], v[200:203], v[88:91]
    ds_read_b128 v[72:75], v236 offset:16768
    ds_read_b64 a[110:111], v11 offset:8624
    v_mfma_f32_16x16x32_bf16 v[96:99], a[204:207], v[204:207], v[96:99]
    ds_read_b128 v[76:79], v224 offset:48
    ds_read_b64 a[112:113], v11 offset:8384
    s_waitcnt lgkmcnt(11)
    v_mfma_f32_16x16x32_bf16 v[88:91], a[208:211], v[172:175], v[88:91]
    ds_read_b128 v[192:195], v225 offset:16784
    ds_read_b64 a[114:115], v11 offset:8640
    v_mfma_f32_16x16x32_bf16 v[96:99], a[208:211], v[176:179], v[96:99]
    ds_read_b128 v[196:199], v236 offset:16784
    ds_read_b64 a[116:117], v11 offset:8400
    v_mfma_f32_16x16x32_bf16 v[104:107], v[188:191], a[200:203], v[104:107]
    ds_read_b128 v[200:203], v225 offset:16800
    ds_read_b64 a[118:119], v11 offset:8656
    v_mfma_f32_16x16x32_bf16 v[88:91], a[212:215], v[180:183], v[88:91]
    ds_read_b128 v[204:207], v236 offset:16800
    ds_read_b64 a[120:121], v11 offset:8416
    v_mfma_f32_16x16x32_bf16 v[96:99], a[212:215], v[184:187], v[96:99]
    ds_read_b128 v[208:211], v224 offset:64
    ds_read_b64 a[122:123], v11 offset:8672
    s_waitcnt lgkmcnt(11)
    v_mfma_f32_16x16x32_bf16 v[88:91], a[216:219], v[60:63], v[88:91]
    ds_read_b128 v[172:175], v225 offset:16816
    ds_read_b64 a[124:125], v11 offset:8432
    v_mfma_f32_16x16x32_bf16 v[96:99], a[216:219], v[64:67], v[96:99]
    ds_read_b128 v[176:179], v236 offset:16816
    ds_read_b64 a[126:127], v11 offset:8688
    v_mfma_f32_16x16x32_bf16 v[104:107], v[76:79], a[204:207], v[104:107]
    ds_read_b128 v[180:183], v225 offset:16832
    s_waitcnt vmcnt(9)
    v_mfma_f32_16x16x32_bf16 v[88:91], a[220:223], v[68:71], v[88:91]
    ds_read_b128 v[184:187], v236 offset:16832
    ds_read_b64 a[128:129], v11 offset:0
    v_mfma_f32_16x16x32_bf16 v[96:99], a[220:223], v[72:75], v[96:99]
    ds_read_b128 v[188:191], v224 offset:80
    ds_read_b64 a[130:131], v11 offset:256
    s_waitcnt lgkmcnt(10)
    v_mfma_f32_16x16x32_bf16 v[88:91], a[224:227], v[192:195], v[88:91]
    ds_read_b128 v[60:63], v225 offset:16848
    ds_read_b64 a[132:133], v11 offset:16
    v_mfma_f32_16x16x32_bf16 v[96:99], a[224:227], v[196:199], v[96:99]
    ds_read_b128 v[64:67], v236 offset:16848
    ds_read_b64 a[134:135], v11 offset:272
    v_mfma_f32_16x16x32_bf16 v[104:107], v[208:211], a[208:211], v[104:107]
    ds_read_b128 v[68:71], v225 offset:16864
    ds_read_b64 a[136:137], v11 offset:32
    v_mfma_f32_16x16x32_bf16 v[88:91], a[228:231], v[200:203], v[88:91]
    ds_read_b128 v[72:75], v236 offset:16864
    ds_read_b64 a[138:139], v11 offset:288
    v_mfma_f32_16x16x32_bf16 v[96:99], a[228:231], v[204:207], v[96:99]
    ds_read_b128 v[76:79], v224 offset:96
    ds_read_b64 a[140:141], v11 offset:48
    s_waitcnt lgkmcnt(11)
    v_mfma_f32_16x16x32_bf16 v[88:91], a[232:235], v[172:175], v[88:91]
    ds_read_b128 v[192:195], v225 offset:16880
    ds_read_b64 a[142:143], v11 offset:304
    s_xor_b32 s89, s72, 8320
    s_add_u32 m0, s73, 8320
    s_nop 0
    buffer_load_dwordx4 v10, s[24:27], s89 offen lds
    v_mfma_f32_16x16x32_bf16 v[96:99], a[232:235], v[176:179], v[96:99]
    ds_read_b128 v[196:199], v236 offset:16880
    ds_read_b64 a[144:145], v11 offset:64
    buffer_load_dwordx4 v28, s[24:27], s89 offen offset:1040 lds
    v_mfma_f32_16x16x32_bf16 v[104:107], v[188:191], a[212:215], v[104:107]
    ds_read_b128 v[200:203], v225 offset:16896
    ds_read_b64 a[146:147], v11 offset:320
    buffer_load_dwordx4 v29, s[24:27], s89 offen offset:2080 lds
    v_mfma_f32_16x16x32_bf16 v[88:91], a[236:239], v[180:183], v[88:91]
    ds_read_b128 v[204:207], v236 offset:16896
    ds_read_b64 a[148:149], v11 offset:80
    buffer_load_dwordx4 v2, s[24:27], s89 offen offset:3120 lds
    v_mfma_f32_16x16x32_bf16 v[96:99], a[236:239], v[184:187], v[96:99]
    ds_read_b128 v[208:211], v224 offset:112
    ds_read_b64 a[150:151], v11 offset:336
    s_xor_b32 s89, s89, 4194304
    s_add_u32 m0, s74, 8320
    s_nop 0
    buffer_load_dwordx4 v10, s[24:27], s89 offen lds
    s_waitcnt lgkmcnt(11)
    s_waitcnt vmcnt(34)
    s_barrier
    ds_read_b128 v[48:51], v231 offset:0
    ds_read_b128 v[52:55], v231 offset:1024
    ds_read_b128 v[56:59], v231 offset:2048
    v_mfma_f32_16x16x32_bf16 v[88:91], a[240:243], v[60:63], v[88:91]
    ds_read_b128 v[172:175], v225 offset:33312
    ds_read_b64 a[152:153], v11 offset:96
    buffer_load_dwordx4 v28, s[24:27], s89 offen offset:1040 lds
    v_mfma_f32_16x16x32_bf16 v[96:99], a[240:243], v[64:67], v[96:99]
    ds_read_b128 v[176:179], v236 offset:33312
    ds_read_b64 a[154:155], v11 offset:352
    buffer_load_dwordx4 v29, s[24:27], s89 offen offset:2080 lds
    v_mfma_f32_16x16x32_bf16 v[104:107], v[76:79], a[216:219], v[104:107]
    ds_read_b128 v[180:183], v225 offset:33328
    ds_read_b64 a[156:157], v11 offset:112
    buffer_load_dwordx4 v2, s[24:27], s89 offen offset:3120 lds
    v_mfma_f32_16x16x32_bf16 v[88:91], a[244:247], v[68:71], v[88:91]
    ds_read_b128 v[184:187], v236 offset:33328
    ds_read_b64 a[158:159], v11 offset:368
    s_add_u32 m0, s6, 66624
    s_add_u32 s87, s96, 32768
    buffer_load_dwordx4 v9, s[28:31], s87 offen lds
    v_mfma_f32_16x16x32_bf16 v[96:99], a[244:247], v[72:75], v[96:99]
    ds_read_b128 v[188:191], v224 offset:128
    buffer_load_dwordx4 v13, s[28:31], s87 offen offset:1024 lds
    s_waitcnt lgkmcnt(13)
    v_mfma_f32_16x16x32_bf16 v[88:91], a[248:251], v[192:195], v[88:91]
    ds_read_b128 v[60:63], v225 offset:33344
    buffer_load_dwordx4 v26, s[28:31], s87 offen offset:2048 lds
    v_mfma_f32_16x16x32_bf16 v[96:99], a[248:251], v[196:199], v[96:99]
    ds_read_b128 v[64:67], v236 offset:33344
    v_mfma_f32_16x16x32_bf16 v[104:107], v[208:211], a[220:223], v[104:107]
    ds_read_b128 v[68:71], v225 offset:33360
    v_mfma_f32_16x16x32_bf16 v[88:91], a[252:255], v[200:203], v[88:91]
    ds_read_b128 v[72:75], v236 offset:33360
    buffer_load_dwordx4 v27, s[28:31], s87 offen offset:3072 lds
    v_mfma_f32_16x16x32_bf16 v[96:99], a[252:255], v[204:207], v[96:99]
    ds_read_b128 v[76:79], v224 offset:144
    s_waitcnt lgkmcnt(5)
    v_mfma_f32_16x16x32_bf16 v[92:95], a[192:195], v[172:175], 0
    ds_read_b128 v[192:195], v225 offset:33376
    v_mfma_f32_16x16x32_bf16 v[100:103], a[192:195], v[176:179], 0
    ds_read_b128 v[196:199], v236 offset:33376
    s_xor_b32 s89, s72, 12288
    s_add_u32 m0, s73, 0
    s_nop 0
    buffer_load_dwordx4 v10, s[24:27], s89 offen lds
    v_mfma_f32_16x16x32_bf16 v[104:107], v[188:191], a[224:227], v[104:107]
    ds_read_b128 v[200:203], v225 offset:33392
    v_mfma_f32_16x16x32_bf16 v[92:95], a[196:199], v[180:183], v[92:95]
    ds_read_b128 v[204:207], v236 offset:33392
    v_mfma_f32_16x16x32_bf16 v[100:103], a[196:199], v[184:187], v[100:103]
    ds_read_b128 v[208:211], v224 offset:160
    buffer_load_dwordx4 v28, s[24:27], s89 offen offset:1040 lds
    s_waitcnt lgkmcnt(5)
    v_mfma_f32_16x16x32_bf16 v[92:95], a[200:203], v[60:63], v[92:95]
    ds_read_b128 v[172:175], v225 offset:33408
    v_mfma_f32_16x16x32_bf16 v[100:103], a[200:203], v[64:67], v[100:103]
    ds_read_b128 v[176:179], v236 offset:33408
    v_mfma_f32_16x16x32_bf16 v[104:107], v[76:79], a[228:231], v[104:107]
    ds_read_b128 v[180:183], v225 offset:33424
    buffer_load_dwordx4 v29, s[24:27], s89 offen offset:2080 lds
    v_mfma_f32_16x16x32_bf16 v[92:95], a[204:207], v[68:71], v[92:95]
    ds_read_b128 v[184:187], v236 offset:33424
    v_mfma_f32_16x16x32_bf16 v[100:103], a[204:207], v[72:75], v[100:103]
    ds_read_b128 v[188:191], v224 offset:176
    s_bitcmp0_b32 s54, 0
    s_cbranch_scc1 L_ex1
    v_swap_b32 v32, v56
    v_swap_b32 v33, v57
    v_swap_b32 v34, v58
    v_swap_b32 v35, v59
    v_swap_b32 v36, v52
    v_swap_b32 v37, v53
    v_swap_b32 v38, v54
    v_swap_b32 v39, v55
    v_swap_b32 v40, v48
    v_swap_b32 v41, v49
    v_swap_b32 v42, v50
    v_swap_b32 v43, v51
L_ex1:
    s_waitcnt lgkmcnt(5)
    v_mfma_f32_16x16x32_bf16 v[92:95], a[208:211], v[192:195], v[92:95]
    ds_read_b128 v[60:63], v225 offset:33440
    buffer_load_dwordx4 v2, s[24:27], s89 offen offset:3120 lds
    v_mfma_f32_16x16x32_bf16 v[100:103], a[208:211], v[196:199], v[100:103]
    ds_read_b128 v[64:67], v236 offset:33440
    v_mfma_f32_16x16x32_bf16 v[104:107], v[208:211], a[232:235], v[104:107]
    ds_read_b128 v[68:71], v225 offset:33456
    v_mfma_f32_16x16x32_bf16 v[92:95], a[212:215], v[200:203], v[92:95]
    ds_read_b128 v[72:75], v236 offset:33456
    s_xor_b32 s89, s89, 4194304
    s_add_u32 m0, s74, 0
    s_nop 0
    buffer_load_dwordx4 v10, s[24:27], s89 offen lds
    v_mfma_f32_16x16x32_bf16 v[100:103], a[212:215], v[204:207], v[100:103]
    ds_read_b128 v[76:79], v224 offset:192
    s_waitcnt lgkmcnt(5)
    v_mfma_f32_16x16x32_bf16 v[92:95], a[216:219], v[172:175], v[92:95]
    ds_read_b128 v[192:195], v225 offset:33472
    v_mfma_f32_16x16x32_bf16 v[100:103], a[216:219], v[176:179], v[100:103]
    ds_read_b128 v[196:199], v236 offset:33472
    buffer_load_dwordx4 v28, s[24:27], s89 offen offset:1040 lds
    v_mfma_f32_16x16x32_bf16 v[104:107], v[188:191], a[236:239], v[104:107]
    ds_read_b128 v[200:203], v225 offset:33488
    v_mfma_f32_16x16x32_bf16 v[92:95], a[220:223], v[180:183], v[92:95]
    ds_read_b128 v[204:207], v236 offset:33488
    v_mfma_f32_16x16x32_bf16 v[100:103], a[220:223], v[184:187], v[100:103]
    ds_read_b128 v[208:211], v224 offset:208
    buffer_load_dwordx4 v29, s[24:27], s89 offen offset:2080 lds
    v_and_b32 v166, 31, v0
    v_lshlrev_b32 v166, 3, v166
    buffer_load_dwordx2 v[164:165], v166, s[36:39], s75 offen sc1
    s_waitcnt lgkmcnt(5)
    v_mfma_f32_16x16x32_bf16 v[92:95], a[224:227], v[60:63], v[92:95]
    ds_read_b128 v[172:175], v225 offset:33504
    v_mfma_f32_16x16x32_bf16 v[100:103], a[224:227], v[64:67], v[100:103]
    ds_read_b128 v[176:179], v236 offset:33504
    v_mfma_f32_16x16x32_bf16 v[104:107], v[76:79], a[240:243], v[104:107]
    ds_read_b128 v[180:183], v225 offset:33520
    buffer_load_dwordx4 v2, s[24:27], s89 offen offset:3120 lds
    v_mfma_f32_16x16x32_bf16 v[92:95], a[228:231], v[68:71], v[92:95]
    ds_read_b128 v[184:187], v236 offset:33520
    v_mfma_f32_16x16x32_bf16 v[100:103], a[228:231], v[72:75], v[100:103]
    ds_read_b128 v[188:191], v224 offset:224
    s_waitcnt lgkmcnt(5)
    v_mfma_f32_16x16x32_bf16 v[92:95], a[232:235], v[192:195], v[92:95]
    ds_read_b128 v[60:63], v225 offset:33536
    v_mfma_f32_16x16x32_bf16 v[100:103], a[232:235], v[196:199], v[100:103]
    ds_read_b128 v[64:67], v236 offset:33536
    v_mfma_f32_16x16x32_bf16 v[104:107], v[208:211], a[244:247], v[104:107]
    ds_read_b128 v[68:71], v225 offset:33552
    v_mfma_f32_16x16x32_bf16 v[92:95], a[236:239], v[200:203], v[92:95]
    ds_read_b128 v[72:75], v236 offset:33552
    s_waitcnt vmcnt(13)
    v_mfma_f32_16x16x32_bf16 v[100:103], a[236:239], v[204:207], v[100:103]
    ds_read_b128 v[76:79], v224 offset:240
    ds_read_b64 a[160:161], v11 offset:8320
    s_waitcnt lgkmcnt(6)
    v_mfma_f32_16x16x32_bf16 v[92:95], a[240:243], v[172:175], v[92:95]
    ds_read_b64 a[162:163], v11 offset:8576
    v_mfma_f32_16x16x32_bf16 v[100:103], a[240:243], v[176:179], v[100:103]
    ds_read_b64 a[164:165], v11 offset:8336
    v_mfma_f32_16x16x32_bf16 v[104:107], v[188:191], a[248:251], v[104:107]
    ds_read_b64 a[166:167], v11 offset:8592
    v_mfma_f32_16x16x32_bf16 v[92:95], a[244:247], v[180:183], v[92:95]
    ds_read_b64 a[168:169], v11 offset:8352
    v_mfma_f32_16x16x32_bf16 v[100:103], a[244:247], v[184:187], v[100:103]
    ds_read_b64 a[170:171], v11 offset:8608
    s_waitcnt lgkmcnt(6)
    v_mfma_f32_16x16x32_bf16 v[92:95], a[248:251], v[60:63], v[92:95]
    ds_read_b64 a[172:173], v11 offset:8368
    v_mfma_f32_16x16x32_bf16 v[100:103], a[248:251], v[64:67], v[100:103]
    ds_read_b64 a[174:175], v11 offset:8624
    v_mfma_f32_16x16x32_bf16 v[104:107], v[76:79], a[252:255], v[104:107]
    ds_read_b64 a[176:177], v11 offset:8384
    v_mfma_f32_16x16x32_bf16 v[92:95], a[252:255], v[68:71], v[92:95]
    ds_read_b64 a[178:179], v11 offset:8640
    v_mfma_f32_16x16x32_bf16 v[100:103], a[252:255], v[72:75], v[100:103]
    ds_read_b64 a[180:181], v11 offset:8400
    s_waitcnt vmcnt(1)
    s_mov_b32 s82, 0
L_zf:
    v_xor_b32 v164, s56, v164
    v_xor_b32 v165, s57, v165
    v_or_b32 v164, v164, v165
    v_cmp_ne_u32 vcc, 0, v164
    s_cbranch_vccz L_zf_ok
    s_add_u32 s82, s82, 1
    s_cmp_ge_u32 s82, 200000
    s_cbranch_scc1 L_zf_ok
    buffer_load_dwordx2 v[164:165], v166, s[36:39], s75 offen sc1
    s_waitcnt vmcnt(0)
    s_branch L_zf
L_zf_ok:
    v_add_u32 v8, s83, v1
    s_lshl_b32 s8, s58, 11
    s_xor_b32 s9, s8, 2048
    s_xor_b32 s10, s8, 4096
    s_xor_b32 s11, s8, 6144
    s_xor_b32 s12, s8, 8192
    s_xor_b32 s13, s8, 10240
    s_xor_b32 s14, s8, 12288
    s_xor_b32 s15, s8, 14336
    s_xor_b32 s16, s8, 16384
    s_xor_b32 s17, s8, 18432
    s_xor_b32 s18, s8, 20480
    s_xor_b32 s19, s8, 22528
    s_xor_b32 s20, s8, 24576
    s_xor_b32 s21, s8, 26624
    s_xor_b32 s22, s8, 28672
    s_xor_b32 s23, s8, 30720
    s_barrier
    v_mul_f32 v14, 0xbfb8aa3b, v104
    ds_read_b64 a[182:183], v11 offset:8656
    buffer_load_dwordx4 v[172:175], v8, s[36:39], s8 offen offset:0 sc1
    v_exp_f32 v14, v14
    ds_read_b64 a[184:185], v11 offset:8416
    buffer_load_dwordx4 v[176:179], v8, s[36:39], s8 offen offset:1024 sc1
    v_add_f32 v14, 1.0, v14
    ds_read_b64 a[186:187], v11 offset:8672
    buffer_load_dwordx4 v[180:183], v8, s[36:39], s9 offen offset:0 sc1
    v_rcp_f32 v6, v14
    ds_read_b64 a[188:189], v11 offset:8432
    buffer_load_dwordx4 v[184:187], v8, s[36:39], s9 offen offset:1024 sc1
    v_cvt_pk_bf16_f32 v108, v88, v89
    ds_read_b64 a[190:191], v11 offset:8688
    buffer_load_dwordx4 v[188:191], v8, s[36:39], s10 offen offset:0 sc1
    v_cvt_pk_bf16_f32 v109, v90, v91
    buffer_load_dwordx4 v[192:195], v8, s[36:39], s10 offen offset:1024 sc1
    v_cvt_pk_bf16_f32 v110, v96, v97
    v_cvt_pk_bf16_f32 v111, v98, v99
    buffer_load_dwordx4 v[196:199], v8, s[36:39], s11 offen offset:0 sc1
    v_cvt_pk_bf16_f32 v112, v92, v93
    v_cvt_pk_bf16_f32 v113, v94, v95
    v_cvt_pk_bf16_f32 v114, v100, v101
    v_cvt_pk_bf16_f32 v115, v102, v103
    v_mfma_f32_16x16x32_bf16 v[60:63], v[240:243], v[108:111], 0
    v_mfma_f32_16x16x32_bf16 v[64:67], v[244:247], v[108:111], 0
    v_mfma_f32_16x16x32_bf16 v[68:71], v[240:243], v[112:115], 0
    v_mfma_f32_16x16x32_bf16 v[72:75], v[244:247], v[112:115], 0
    v_lshlrev_b32 v24, 10, v4
    v_lshl_add_u32 v24, v3, 4, v24
    s_lshl_b32 s76, s55, 2
    s_add_u32 s76, s76, 151552
    v_add_u32 v24, s76, v24
    buffer_load_dwordx4 v[200:203], v8, s[36:39], s11 offen offset:1024 sc1
    s_cmp_lg_u32 s53, 0
    s_cbranch_scc1 L_nofix
    v_mfma_f32_16x16x32_bf16 v[76:79], v[248:251], v[108:111], 0
    v_mfma_f32_16x16x32_bf16 v[80:83], v[252:255], v[108:111], 0
    s_lshl_b32 s76, s52, 2
    s_add_u32 s76, s76, s55
    s_lshl_b32 s76, s76, 6
    s_add_u32 s76, s76, 13107200
    v_lshlrev_b32 v14, 2, v3
    s_mov_b64 exec, 0xffff
    buffer_store_dword v6, v14, s[36:39], s76 offen sc1
    s_mov_b64 exec, s[68:69]
    v_add_f32 v14, v60, v76
    v_add_f32 v15, v64, v80
    v_sub_f32 v16, v64, v80
    v_sub_f32 v17, v76, v60
    v_mul_f32 v60, 0.5, v14
    v_mul_f32 v64, 0.5, v15
    v_mul_f32 v16, 0.5, v16
    v_mul_f32 v17, 0.5, v17
    v_cvt_pk_bf16_f32 v16, v16, v17
    ds_write_b32 v24, v16 offset:8192
    v_add_f32 v14, v61, v77
    v_add_f32 v15, v65, v81
    v_sub_f32 v16, v65, v81
    v_sub_f32 v17, v77, v61
    v_mul_f32 v61, 0.5, v14
    v_mul_f32 v65, 0.5, v15
    v_mul_f32 v16, 0.5, v16
    v_mul_f32 v17, 0.5, v17
    v_cvt_pk_bf16_f32 v16, v16, v17
    ds_write_b32 v24, v16 offset:8448
    v_add_f32 v14, v62, v78
    v_add_f32 v15, v66, v82
    v_sub_f32 v16, v66, v82
    v_sub_f32 v17, v78, v62
    v_mul_f32 v62, 0.5, v14
    v_mul_f32 v66, 0.5, v15
    v_mul_f32 v16, 0.5, v16
    v_mul_f32 v17, 0.5, v17
    v_cvt_pk_bf16_f32 v16, v16, v17
    ds_write_b32 v24, v16 offset:8704
    v_add_f32 v14, v63, v79
    v_add_f32 v15, v67, v83
    v_sub_f32 v16, v67, v83
    v_sub_f32 v17, v79, v63
    v_mul_f32 v63, 0.5, v14
    v_mul_f32 v67, 0.5, v15
    v_mul_f32 v16, 0.5, v16
    v_mul_f32 v17, 0.5, v17
    v_cvt_pk_bf16_f32 v16, v16, v17
    ds_write_b32 v24, v16 offset:8960
    s_mov_b64 exec, -1
L_nofix:
    s_nop 7
    v_cvt_pk_bf16_f32 v16, v60, v64
    s_waitcnt lgkmcnt(0)
    ds_write_b32 v24, v16 offset:0
    v_cvt_pk_bf16_f32 v17, v61, v65
    ds_write_b32 v24, v17 offset:256
    v_cvt_pk_bf16_f32 v18, v62, v66
    ds_write_b32 v24, v18 offset:512
    s_xor_b32 s89, s72, 12416
    s_add_u32 m0, s73, 8320
    s_nop 0
    buffer_load_dwordx4 v10, s[24:27], s89 offen lds
    v_cvt_pk_bf16_f32 v19, v63, v67
    ds_write_b32 v24, v19 offset:768
    v_cvt_pk_bf16_f32 v20, v68, v72
    ds_write_b32 v24, v20 offset:4096
    v_cvt_pk_bf16_f32 v21, v69, v73
    ds_write_b32 v24, v21 offset:4352
    buffer_load_dwordx4 v28, s[24:27], s89 offen offset:1040 lds
    v_cvt_pk_bf16_f32 v22, v70, v74
    ds_write_b32 v24, v22 offset:4608
    v_cvt_pk_bf16_f32 v23, v71, v75
    ds_write_b32 v24, v23 offset:4864
    s_waitcnt lgkmcnt(0)
    s_barrier
    s_add_u32 s76, s59, 151552
    v_add_u32 v14, s76, v1
    ds_read_b128 v[60:63], v14 offset:0
    ds_read_b128 v[64:67], v14 offset:4096
    ds_read_b128 v[68:71], v14 offset:8192
    s_lshl_b32 s77, s52, 8
    s_add_u32 s77, s77, 8388608
    s_lshl_b32 s76, s53, 14
    s_add_u32 s76, s76, s77
    s_add_u32 s78, s76, 8192
    s_add_u32 s77, s77, 131072
    s_cmp_eq_u32 s53, 0
    s_cselect_b32 s77, s77, 16777216
    s_mov_b32 s4, 0xbdd2d3e8
    s_waitcnt vmcnt(10)
    buffer_load_dwordx4 v29, s[24:27], s89 offen offset:2080 lds
    s_mov_b32 s5, 0xbdd2d3e8
    ds_read_b64 a[192:193], v11 offset:0
    buffer_load_dwordx4 v2, s[24:27], s89 offen offset:3120 lds
    v_mov_b32 v22, 0xc0135761
    ds_read_b64 a[194:195], v11 offset:256
    s_xor_b32 s89, s89, 4194304
    s_add_u32 m0, s74, 8320
    s_nop 0
    buffer_load_dwordx4 v10, s[24:27], s89 offen lds
    v_mov_b32 v23, 0xc0135761
    ds_read_b64 a[196:197], v11 offset:16
    v_pk_mul_f32 v[14:15], v[32:33], v[32:33]
    ds_read_b64 a[198:199], v11 offset:272
    v_pk_mul_f32 v[16:17], v[34:35], v[34:35]
    ds_read_b64 a[200:201], v11 offset:32
    v_pk_fma_f32 v[14:15], v[14:15], s[4:5], v[22:23]
    ds_read_b64 a[202:203], v11 offset:288
    buffer_load_dwordx4 v28, s[24:27], s89 offen offset:1040 lds
    v_pk_fma_f32 v[16:17], v[16:17], s[4:5], v[22:23]
    ds_read_b64 a[204:205], v11 offset:48
    v_pk_mul_f32 v[14:15], v[14:15], v[32:33]
    ds_read_b64 a[206:207], v11 offset:304
    v_pk_mul_f32 v[16:17], v[16:17], v[34:35]
    ds_read_b64 a[208:209], v11 offset:64
    v_exp_f32 v14, v14
    ds_read_b64 a[210:211], v11 offset:320
    buffer_load_dwordx4 v29, s[24:27], s89 offen offset:2080 lds
    v_exp_f32 v15, v15
    ds_read_b64 a[212:213], v11 offset:80
    v_exp_f32 v16, v16
    ds_read_b64 a[214:215], v11 offset:336
    v_exp_f32 v17, v17
    ds_read_b64 a[216:217], v11 offset:96
    v_pk_add_f32 v[14:15], v[14:15], 1.0 op_sel_hi:[1,0]
    ds_read_b64 a[218:219], v11 offset:352
    buffer_load_dwordx4 v2, s[24:27], s89 offen offset:3120 lds
    v_pk_add_f32 v[16:17], v[16:17], 1.0 op_sel_hi:[1,0]
    ds_read_b64 a[220:221], v11 offset:112
    v_rcp_f32 v14, v14
    ds_read_b64 a[222:223], v11 offset:368
    v_rcp_f32 v15, v15
    v_rcp_f32 v16, v16
    v_rcp_f32 v17, v17
    buffer_load_dwordx4 v[204:207], v8, s[36:39], s12 offen offset:0 sc1
    v_pk_mul_f32 v[32:33], v[32:33], v[14:15]
    v_pk_mul_f32 v[34:35], v[34:35], v[16:17]
    v_pk_mul_f32 v[14:15], v[36:37], v[36:37]
    v_pk_mul_f32 v[16:17], v[38:39], v[38:39]
    v_pk_fma_f32 v[14:15], v[14:15], s[4:5], v[22:23]
    v_pk_fma_f32 v[16:17], v[16:17], s[4:5], v[22:23]
    v_pk_mul_f32 v[14:15], v[14:15], v[36:37]
    v_pk_mul_f32 v[16:17], v[16:17], v[38:39]
    v_exp_f32 v14, v14
    v_exp_f32 v15, v15
    buffer_load_dwordx4 v[208:211], v8, s[36:39], s12 offen offset:1024 sc1
    v_exp_f32 v16, v16
    s_waitcnt lgkmcnt(0)
    v_exp_f32 v17, v17
    v_pk_add_f32 v[14:15], v[14:15], 1.0 op_sel_hi:[1,0]
    v_pk_add_f32 v[16:17], v[16:17], 1.0 op_sel_hi:[1,0]
    v_rcp_f32 v14, v14
    v_rcp_f32 v15, v15
    v_rcp_f32 v16, v16
    buffer_load_dwordx4 v[212:215], v8, s[36:39], s13 offen offset:0 sc1
    v_rcp_f32 v17, v17
    v_pk_mul_f32 v[36:37], v[36:37], v[14:15]
    v_pk_mul_f32 v[38:39], v[38:39], v[16:17]
    v_pk_mul_f32 v[14:15], v[40:41], v[40:41]
    v_pk_mul_f32 v[16:17], v[42:43], v[42:43]
    v_pk_fma_f32 v[14:15], v[14:15], s[4:5], v[22:23]
    v_pk_fma_f32 v[16:17], v[16:17], s[4:5], v[22:23]
    v_pk_mul_f32 v[14:15], v[14:15], v[40:41]
    v_pk_mul_f32 v[16:17], v[16:17], v[42:43]
    v_exp_f32 v14, v14
    buffer_load_dwordx4 v[216:219], v8, s[36:39], s13 offen offset:1024 sc1
    v_exp_f32 v15, v15
    v_exp_f32 v16, v16
    v_exp_f32 v17, v17
    v_pk_add_f32 v[14:15], v[14:15], 1.0 op_sel_hi:[1,0]
    v_pk_add_f32 v[16:17], v[16:17], 1.0 op_sel_hi:[1,0]
    v_rcp_f32 v14, v14
    v_rcp_f32 v15, v15
    buffer_load_dwordx4 v[220:223], v8, s[36:39], s14 offen offset:0 sc1
    v_rcp_f32 v16, v16
    v_rcp_f32 v17, v17
    v_pk_mul_f32 v[40:41], v[40:41], v[14:15]
    v_pk_mul_f32 v[42:43], v[42:43], v[16:17]
    v_pk_mul_f32 v[14:15], v[44:45], v[44:45]
    v_pk_mul_f32 v[16:17], v[46:47], v[46:47]
    v_pk_fma_f32 v[14:15], v[14:15], s[4:5], v[22:23]
    v_pk_fma_f32 v[16:17], v[16:17], s[4:5], v[22:23]
    v_pk_mul_f32 v[14:15], v[14:15], v[44:45]
    buffer_load_dwordx4 v[224:227], v8, s[36:39], s14 offen offset:1024 sc1
    v_pk_mul_f32 v[16:17], v[16:17], v[46:47]
    v_exp_f32 v14, v14
    v_exp_f32 v15, v15
    v_exp_f32 v16, v16
    v_exp_f32 v17, v17
    v_pk_add_f32 v[14:15], v[14:15], 1.0 op_sel_hi:[1,0]
    v_pk_add_f32 v[16:17], v[16:17], 1.0 op_sel_hi:[1,0]
    v_rcp_f32 v14, v14
    buffer_load_dwordx4 v[228:231], v8, s[36:39], s15 offen offset:0 sc1
    v_rcp_f32 v15, v15
    v_rcp_f32 v16, v16
    v_rcp_f32 v17, v17
    v_pk_mul_f32 v[44:45], v[44:45], v[14:15]
    v_pk_mul_f32 v[46:47], v[46:47], v[16:17]
    v_pk_mul_f32 v[14:15], v[48:49], v[48:49]
    v_pk_mul_f32 v[16:17], v[50:51], v[50:51]
    v_pk_fma_f32 v[14:15], v[14:15], s[4:5], v[22:23]
    v_pk_fma_f32 v[16:17], v[16:17], s[4:5], v[22:23]
    buffer_load_dwordx4 v[232:235], v8, s[36:39], s15 offen offset:1024 sc1
    v_pk_mul_f32 v[14:15], v[14:15], v[48:49]
    v_pk_mul_f32 v[16:17], v[16:17], v[50:51]
    v_exp_f32 v14, v14
    v_exp_f32 v15, v15
    v_exp_f32 v16, v16
    v_exp_f32 v17, v17
    v_pk_add_f32 v[14:15], v[14:15], 1.0 op_sel_hi:[1,0]
    v_pk_add_f32 v[16:17], v[16:17], 1.0 op_sel_hi:[1,0]
    buffer_load_dwordx4 v[236:239], v8, s[36:39], s16 offen offset:0 sc1
    v_rcp_f32 v14, v14
    v_rcp_f32 v15, v15
    v_rcp_f32 v16, v16
    v_rcp_f32 v17, v17
    v_pk_mul_f32 v[48:49], v[48:49], v[14:15]
    v_pk_mul_f32 v[50:51], v[50:51], v[16:17]
    v_pk_mul_f32 v[14:15], v[52:53], v[52:53]
    v_pk_mul_f32 v[16:17], v[54:55], v[54:55]
    v_pk_fma_f32 v[14:15], v[14:15], s[4:5], v[22:23]
    buffer_load_dwordx4 v[240:243], v8, s[36:39], s16 offen offset:1024 sc1
    v_pk_fma_f32 v[16:17], v[16:17], s[4:5], v[22:23]
    v_pk_mul_f32 v[14:15], v[14:15], v[52:53]
    v_pk_mul_f32 v[16:17], v[16:17], v[54:55]
    v_exp_f32 v14, v14
    v_exp_f32 v15, v15
    v_exp_f32 v16, v16
    v_exp_f32 v17, v17
    v_pk_add_f32 v[14:15], v[14:15], 1.0 op_sel_hi:[1,0]
    buffer_load_dwordx4 v[244:247], v8, s[36:39], s17 offen offset:0 sc1
    v_pk_add_f32 v[16:17], v[16:17], 1.0 op_sel_hi:[1,0]
    v_rcp_f32 v14, v14
    v_rcp_f32 v15, v15
    v_rcp_f32 v16, v16
    v_rcp_f32 v17, v17
    v_pk_mul_f32 v[52:53], v[52:53], v[14:15]
    v_pk_mul_f32 v[54:55], v[54:55], v[16:17]
    v_pk_mul_f32 v[14:15], v[56:57], v[56:57]
    buffer_load_dwordx4 v[248:251], v8, s[36:39], s17 offen offset:1024 sc1
    v_pk_mul_f32 v[16:17], v[58:59], v[58:59]
    v_pk_fma_f32 v[14:15], v[14:15], s[4:5], v[22:23]
    v_pk_fma_f32 v[16:17], v[16:17], s[4:5], v[22:23]
    v_pk_mul_f32 v[14:15], v[14:15], v[56:57]
    v_pk_mul_f32 v[16:17], v[16:17], v[58:59]
    v_exp_f32 v14, v14
    v_exp_f32 v15, v15
    v_exp_f32 v16, v16
    v_exp_f32 v17, v17
    buffer_load_dwordx4 v[252:255], v8, s[36:39], s18 offen offset:0 sc1
    v_pk_add_f32 v[14:15], v[14:15], 1.0 op_sel_hi:[1,0]
    v_pk_add_f32 v[16:17], v[16:17], 1.0 op_sel_hi:[1,0]
    v_rcp_f32 v14, v14
    v_rcp_f32 v15, v15
    v_rcp_f32 v16, v16
    v_rcp_f32 v17, v17
    v_pk_mul_f32 v[56:57], v[56:57], v[14:15]
    v_pk_mul_f32 v[58:59], v[58:59], v[16:17]
    s_add_u32 m0, s6, 83280
    s_add_u32 s87, s96, 262144
    buffer_load_dwordx4 v9, s[28:31], s87 offen lds
    v_sub_f32 v24, 1.0, v6
    v_mov_b32 v25, v24
    v_pk_mul_f32 v[32:33], v[32:33], v[24:25]
    v_pk_mul_f32 v[34:35], v[34:35], v[24:25]
    v_pk_mul_f32 v[36:37], v[36:37], v[24:25]
    v_pk_mul_f32 v[38:39], v[38:39], v[24:25]
    v_pk_mul_f32 v[40:41], v[40:41], v[24:25]
    v_pk_mul_f32 v[42:43], v[42:43], v[24:25]
    s_waitcnt vmcnt(14)
    v_pk_mul_f32 v[44:45], v[44:45], v[24:25]
    ds_read_b64 a[224:225], v11 offset:8320
    buffer_load_dwordx4 v13, s[28:31], s87 offen offset:1024 lds
    v_pk_mul_f32 v[46:47], v[46:47], v[24:25]
    ds_read_b64 a[226:227], v11 offset:8576
    v_pk_mul_f32 v[48:49], v[48:49], v[24:25]
    ds_read_b64 a[228:229], v11 offset:8336
    v_pk_mul_f32 v[50:51], v[50:51], v[24:25]
    ds_read_b64 a[230:231], v11 offset:8592
    buffer_load_dwordx4 v26, s[28:31], s87 offen offset:2048 lds
    v_pk_mul_f32 v[52:53], v[52:53], v[24:25]
    ds_read_b64 a[232:233], v11 offset:8352
    v_pk_mul_f32 v[54:55], v[54:55], v[24:25]
    ds_read_b64 a[234:235], v11 offset:8608
    v_pk_mul_f32 v[56:57], v[56:57], v[24:25]
    ds_read_b64 a[236:237], v11 offset:8368
    v_pk_mul_f32 v[58:59], v[58:59], v[24:25]
    ds_read_b64 a[238:239], v11 offset:8624
    buffer_load_dwordx4 v27, s[28:31], s87 offen offset:3072 lds
    v_lshlrev_b32 v156, 16, v5
    ds_read_b64 a[240:241], v11 offset:8384
    v_mov_b32 v157, v156
    ds_read_b64 a[242:243], v11 offset:8640
    v_mov_b32 v158, v156
    ds_read_b64 a[244:245], v11 offset:8400
    v_mov_b32 v159, v156
    ds_read_b64 a[246:247], v11 offset:8656
    s_add_u32 m0, s6, 99936
    s_add_u32 s87, s96, 65536
    buffer_load_dwordx4 v9, s[28:31], s87 offen lds
    ds_read_b64 a[248:249], v11 offset:8416
    ds_read_b64 a[250:251], v11 offset:8672
    ds_read_b64 a[252:253], v11 offset:8432
    ds_read_b64 a[254:255], v11 offset:8688
    buffer_load_dwordx4 v13, s[28:31], s87 offen offset:1024 lds
    buffer_load_dwordx4 v26, s[28:31], s87 offen offset:2048 lds
    s_waitcnt lgkmcnt(0)
    buffer_load_dwordx4 v27, s[28:31], s87 offen offset:3072 lds
    s_waitcnt lgkmcnt(0)
    buffer_store_dwordx4 v[60:63], v7, s[36:39], s76 offen sc1
    buffer_store_dwordx4 v[64:67], v7, s[36:39], s78 offen sc1
    s_mov_b64 exec, s[68:69]
    buffer_store_dwordx4 v[68:71], v7, s[36:39], s77 offen sc1
    s_mov_b64 exec, -1
    s_waitcnt vmcnt(38)
    v_mfma_f32_16x16x32_bf16 v[68:71], v[172:175], a[64:67], 0
    v_mov_b32 v160, -1
    v_mfma_f32_16x16x32_bf16 v[76:79], v[172:175], a[128:131], 0
    v_mov_b32 v161, -1
    v_mfma_f32_16x16x32_bf16 v[84:87], v[172:175], a[192:195], 0
    v_mov_b32 v162, -1
    v_mfma_f32_16x16x32_bf16 v[60:63], v[172:175], a[0:3], v[156:159]
    buffer_load_dwordx4 v[172:175], v8, s[36:39], s18 offen offset:1024 sc1
    v_mfma_f32_16x16x32_bf16 v[72:75], v[176:179], a[64:67], 0
    v_mov_b32 v163, -1
    v_mfma_f32_16x16x32_bf16 v[80:83], v[176:179], a[128:131], 0
    s_xor_b32 s77, s54, 1
    s_mul_i32 s77, s77, 6144
    v_mfma_f32_16x16x32_bf16 v[88:91], v[176:179], a[192:195], 0
    s_add_u32 s76, s85, 0
    buffer_store_dwordx4 v[160:163], v1, s[36:39], s76 offen sc1
    v_mfma_f32_16x16x32_bf16 v[64:67], v[176:179], a[0:3], v[156:159]
    buffer_load_dwordx4 v[176:179], v8, s[36:39], s19 offen offset:0 sc1
    s_waitcnt vmcnt(39)
    v_mfma_f32_16x16x32_bf16 v[68:71], v[180:183], a[68:71], v[68:71]
    v_add_u32 v10, s77, v1
    v_mfma_f32_16x16x32_bf16 v[76:79], v[180:183], a[132:135], v[76:79]
    s_xor_b32 s77, s54, 2
    s_mul_i32 s77, s77, 6144
    v_mfma_f32_16x16x32_bf16 v[84:87], v[180:183], a[196:199], v[84:87]
    v_add_u32 v28, s77, v1
    v_mfma_f32_16x16x32_bf16 v[60:63], v[180:183], a[4:7], v[60:63]
    buffer_load_dwordx4 v[180:183], v8, s[36:39], s19 offen offset:1024 sc1
    v_mfma_f32_16x16x32_bf16 v[72:75], v[184:187], a[68:71], v[72:75]
    s_xor_b32 s77, s54, 3
    s_mul_i32 s77, s77, 6144
    v_mfma_f32_16x16x32_bf16 v[80:83], v[184:187], a[132:135], v[80:83]
    v_add_u32 v29, s77, v1
    v_mfma_f32_16x16x32_bf16 v[88:91], v[184:187], a[196:199], v[88:91]
    s_mul_i32 s77, s54, 6144
    v_add_u32 v2, s77, v1
    v_mfma_f32_16x16x32_bf16 v[64:67], v[184:187], a[4:7], v[64:67]
    buffer_load_dwordx4 v[184:187], v8, s[36:39], s20 offen offset:0 sc1
    s_waitcnt vmcnt(39)
    v_mfma_f32_16x16x32_bf16 v[68:71], v[188:191], a[72:75], v[68:71]
    s_lshl_b32 s77, s54, 5
    s_add_u32 s90, s77, s52
    v_mfma_f32_16x16x32_bf16 v[76:79], v[188:191], a[136:139], v[76:79]
    s_add_u32 s76, s85, 8192
    buffer_store_dwordx4 v[160:163], v1, s[36:39], s76 offen sc1
    v_mfma_f32_16x16x32_bf16 v[84:87], v[188:191], a[200:203], v[84:87]
    s_xor_b32 s91, s90, 32
    s_barrier
    v_mfma_f32_16x16x32_bf16 v[60:63], v[188:191], a[8:11], v[60:63]
    buffer_load_dwordx4 v[188:191], v8, s[36:39], s20 offen offset:1024 sc1
    v_mfma_f32_16x16x32_bf16 v[72:75], v[192:195], a[72:75], v[72:75]
    s_sub_u32 s77, 0, s52
    s_lshl_b32 s78, s53, 2
    s_sub_u32 s80, 31, s78
    s_cmp_lt_u32 s53, 4
    s_cselect_b32 s77, s52, s77
    s_cselect_b32 s78, s78, s80
    s_cselect_b32 s94, 1, -1
    s_cselect_b64 vcc, -1, 0
    v_mfma_f32_16x16x32_bf16 v[80:83], v[192:195], a[136:139], v[80:83]
    s_lshl_b32 s94, s94, 13
    s_and_b32 s77, s77, 15
    s_add_u32 m0, s6, 0
    s_add_u32 s87, s96, 294912
    buffer_load_dwordx4 v9, s[28:31], s87 offen lds
    v_mfma_f32_16x16x32_bf16 v[88:91], v[192:195], a[200:203], v[88:91]
    s_mul_i32 s80, s77, 139264
    s_lshl_b32 s78, s78, 13
    v_mfma_f32_16x16x32_bf16 v[64:67], v[192:195], a[8:11], v[64:67]
    buffer_load_dwordx4 v[192:195], v8, s[36:39], s21 offen offset:0 sc1
    s_waitcnt vmcnt(41)
    v_mfma_f32_16x16x32_bf16 v[68:71], v[196:199], a[76:79], v[68:71]
    s_add_u32 s80, s80, s78
    s_and_b32 s77, s54, 1
    v_mfma_f32_16x16x32_bf16 v[76:79], v[196:199], a[140:143], v[76:79]
    s_lshl_b32 s77, s77, 12
    s_add_u32 s80, s80, s77
    v_mfma_f32_16x16x32_bf16 v[84:87], v[196:199], a[204:207], v[84:87]
    s_add_u32 s76, s85, 16384
    buffer_store_dwordx4 v[160:163], v1, s[36:39], s76 offen sc1
    v_mfma_f32_16x16x32_bf16 v[60:63], v[196:199], a[12:15], v[60:63]
    buffer_load_dwordx4 v[196:199], v8, s[36:39], s21 offen offset:1024 sc1
    v_mfma_f32_16x16x32_bf16 v[72:75], v[200:203], a[76:79], v[72:75]
    s_add_u32 s80, s80, 8388608
    v_sub_u32 v14, 16, v3
    v_mfma_f32_16x16x32_bf16 v[80:83], v[200:203], a[140:143], v[80:83]
    v_lshrrev_b32 v15, 4, v14
    v_mfma_f32_16x16x32_bf16 v[88:91], v[200:203], a[204:207], v[88:91]
    v_and_b32 v14, 15, v14
    v_mfma_f32_16x16x32_bf16 v[64:67], v[200:203], a[12:15], v[64:67]
    buffer_load_dwordx4 v[200:203], v8, s[36:39], s22 offen offset:0 sc1
    s_waitcnt vmcnt(34)
    v_mfma_f32_16x16x32_bf16 v[68:71], v[204:207], a[80:83], v[68:71]
    v_lshl_add_u32 v14, v15, 9, v14
    v_mfma_f32_16x16x32_bf16 v[76:79], v[204:207], a[144:147], v[76:79]
    v_cndmask_b32 v14, v14, v3, vcc
    v_mfma_f32_16x16x32_bf16 v[84:87], v[204:207], a[208:211], v[84:87]
    v_lshlrev_b32 v14, 4, v14
    v_mfma_f32_16x16x32_bf16 v[60:63], v[204:207], a[16:19], v[60:63]
    buffer_load_dwordx4 v[204:207], v8, s[36:39], s22 offen offset:1024 sc1
    v_mfma_f32_16x16x32_bf16 v[72:75], v[208:211], a[80:83], v[72:75]
    v_lshl_add_u32 v5, v4, 8, v14
    v_mfma_f32_16x16x32_bf16 v[80:83], v[208:211], a[144:147], v[80:83]
    s_lshr_b32 s79, s77, 1
    s_add_u32 s77, s77, 4194304
    v_mfma_f32_16x16x32_bf16 v[88:91], v[208:211], a[208:211], v[88:91]
    s_mul_i32 s92, s90, 28672
    s_mov_b64 exec, s[66:67]
    buffer_store_dwordx4 v[160:163], v1, s[36:39], s86 offen sc1
    s_mov_b64 exec, -1
    v_mfma_f32_16x16x32_bf16 v[64:67], v[208:211], a[16:19], v[64:67]
    buffer_load_dwordx4 v[208:211], v8, s[36:39], s23 offen offset:0 sc1
    s_waitcnt vmcnt(35)
    v_mfma_f32_16x16x32_bf16 v[68:71], v[212:215], a[84:87], v[68:71]
    s_add_u32 s79, s79, s92
    s_add_u32 s79, s79, 4218880
    v_mfma_f32_16x16x32_bf16 v[76:79], v[212:215], a[148:151], v[76:79]
    s_add_u32 s92, s92, s77
    s_mul_i32 s93, s91, 28672
    buffer_load_dwordx4 v13, s[28:31], s87 offen offset:1024 lds
    v_mfma_f32_16x16x32_bf16 v[84:87], v[212:215], a[212:215], v[84:87]
    s_add_u32 s93, s93, s77
    v_lshrrev_b32 v14, 2, v3
    v_mfma_f32_16x16x32_bf16 v[60:63], v[212:215], a[20:23], v[60:63]
    buffer_load_dwordx4 v[212:215], v8, s[36:39], s23 offen offset:1024 sc1
    v_mfma_f32_16x16x32_bf16 v[72:75], v[216:219], a[84:87], v[72:75]
    v_and_b32 v15, 1, v4
    v_mfma_f32_16x16x32_bf16 v[80:83], v[216:219], a[148:151], v[80:83]
    v_lshrrev_b32 v16, 3, v3
    v_mfma_f32_16x16x32_bf16 v[88:91], v[216:219], a[212:215], v[88:91]
    v_lshl_add_u32 v16, v15, 1, v16
    v_mfma_f32_16x16x32_bf16 v[64:67], v[216:219], a[20:23], v[64:67]
    v_add_u32 v8, 32768, v8
    buffer_load_dwordx4 v[216:219], v8, s[36:39], s8 offen offset:0 sc1
    s_waitcnt vmcnt(36)
    v_mfma_f32_16x16x32_bf16 v[68:71], v[220:223], a[88:91], v[68:71]
    v_and_b32 v17, 3, v3
    v_mfma_f32_16x16x32_bf16 v[76:79], v[220:223], a[152:155], v[76:79]
    v_lshlrev_b32 v17, 3, v17
    v_mfma_f32_16x16x32_bf16 v[84:87], v[220:223], a[216:219], v[84:87]
    s_and_b32 s77, s54, 1
    s_lshl_b32 s77, s77, 13
    v_mfma_f32_16x16x32_bf16 v[60:63], v[220:223], a[24:27], v[60:63]
    buffer_load_dwordx4 v[220:223], v8, s[36:39], s8 offen offset:1024 sc1
    v_mfma_f32_16x16x32_bf16 v[72:75], v[224:227], a[88:91], v[72:75]
    v_add_u32 v17, s77, v17
    v_mfma_f32_16x16x32_bf16 v[80:83], v[224:227], a[152:155], v[80:83]
    v_lshl_add_u32 v14, v4, 2, v14
    v_mfma_f32_16x16x32_bf16 v[88:91], v[224:227], a[216:219], v[88:91]
    v_lshl_add_u32 v14, v14, 7, v17
    v_mfma_f32_16x16x32_bf16 v[64:67], v[224:227], a[24:27], v[64:67]
    buffer_load_dwordx4 v[224:227], v8, s[36:39], s9 offen offset:0 sc1
    s_waitcnt vmcnt(36)
    v_mfma_f32_16x16x32_bf16 v[68:71], v[228:231], a[92:95], v[68:71]
    v_lshlrev_b32 v25, 2, v3
    v_mfma_f32_16x16x32_bf16 v[76:79], v[228:231], a[156:159], v[76:79]
    v_xor_b32 v15, 0, v16
    v_mfma_f32_16x16x32_bf16 v[84:87], v[228:231], a[220:223], v[84:87]
    v_lshl_add_u32 v7, v15, 5, v14
    v_mfma_f32_16x16x32_bf16 v[60:63], v[228:231], a[28:31], v[60:63]
    buffer_load_dwordx4 v[228:231], v8, s[36:39], s9 offen offset:1024 sc1
    v_mfma_f32_16x16x32_bf16 v[72:75], v[232:235], a[92:95], v[72:75]
    v_xor_b32 v15, 1, v16
    v_mfma_f32_16x16x32_bf16 v[80:83], v[232:235], a[156:159], v[80:83]
    v_lshl_add_u32 v11, v15, 5, v14
    buffer_load_dwordx4 v26, s[28:31], s87 offen offset:2048 lds
    v_mfma_f32_16x16x32_bf16 v[88:91], v[232:235], a[220:223], v[88:91]
    v_xor_b32 v15, 2, v16
    v_mfma_f32_16x16x32_bf16 v[64:67], v[232:235], a[28:31], v[64:67]
    buffer_load_dwordx4 v[232:235], v8, s[36:39], s10 offen offset:0 sc1
    s_waitcnt vmcnt(37)
    v_mfma_f32_16x16x32_bf16 v[68:71], v[236:239], a[96:99], v[68:71]
    v_lshl_add_u32 v12, v15, 5, v14
    v_mfma_f32_16x16x32_bf16 v[76:79], v[236:239], a[160:163], v[76:79]
    v_xor_b32 v15, 3, v16
    v_mfma_f32_16x16x32_bf16 v[84:87], v[236:239], a[224:227], v[84:87]
    v_lshl_add_u32 v24, v15, 5, v14
    v_mfma_f32_16x16x32_bf16 v[60:63], v[236:239], a[32:35], v[60:63]
    buffer_load_dwordx4 v[236:239], v8, s[36:39], s10 offen offset:1024 sc1
    v_mfma_f32_16x16x32_bf16 v[72:75], v[240:243], a[96:99], v[72:75]
    s_lshl_b32 s44, s54, 5
    s_add_u32 s44, s44, s52
    s_xor_b32 s45, s44, 32
    s_cmp_lt_u32 s53, 4
    s_cselect_b32 s4, 0, 0x80000000
    v_mfma_f32_16x16x32_bf16 v[80:83], v[240:243], a[160:163], v[80:83]
    s_and_b32 s46, s54, 1
    v_mfma_f32_16x16x32_bf16 v[88:91], v[240:243], a[224:227], v[88:91]
    s_lshl_b32 s46, s46, 6
    v_mfma_f32_16x16x32_bf16 v[64:67], v[240:243], a[32:35], v[64:67]
    buffer_load_dwordx4 v[240:243], v8, s[36:39], s11 offen offset:0 sc1
    s_waitcnt vmcnt(37)
    v_mfma_f32_16x16x32_bf16 v[68:71], v[244:247], a[100:103], v[68:71]
    v_lshl_add_u32 v164, v4, 2, s46
    v_mfma_f32_16x16x32_bf16 v[76:79], v[244:247], a[164:167], v[76:79]
    v_cvt_f32_u32 v164, v164
    v_mfma_f32_16x16x32_bf16 v[84:87], v[244:247], a[228:231], v[84:87]
    v_lshl_add_u32 v165, v3, 7, s44
    v_mfma_f32_16x16x32_bf16 v[60:63], v[244:247], a[36:39], v[60:63]
    buffer_load_dwordx4 v[244:247], v8, s[36:39], s11 offen offset:1024 sc1
    v_mfma_f32_16x16x32_bf16 v[72:75], v[248:251], a[100:103], v[72:75]
    v_cvt_f32_u32 v165, v165
    v_mfma_f32_16x16x32_bf16 v[80:83], v[248:251], a[164:167], v[80:83]
    v_mul_f32 v165, 0x3a000000, v165
    v_mfma_f32_16x16x32_bf16 v[88:91], v[248:251], a[228:231], v[88:91]
    v_xor_b32 v165, s4, v165
    v_mfma_f32_16x16x32_bf16 v[64:67], v[248:251], a[36:39], v[64:67]
    buffer_load_dwordx4 v[248:251], v8, s[36:39], s12 offen offset:0 sc1
    s_waitcnt vmcnt(26)
    v_mfma_f32_16x16x32_bf16 v[68:71], v[252:255], a[104:107], v[68:71]
    v_mul_f32 v166, v164, v165
    v_mfma_f32_16x16x32_bf16 v[76:79], v[252:255], a[168:171], v[76:79]
    v_fmamk_f32 v168, v165, 0x00000000, v166
    buffer_load_dwordx4 v27, s[28:31], s87 offen offset:3072 lds
    v_mfma_f32_16x16x32_bf16 v[84:87], v[252:255], a[232:235], v[84:87]
    v_fmamk_f32 v169, v165, 0x3f800000, v166
    v_mfma_f32_16x16x32_bf16 v[60:63], v[252:255], a[40:43], v[60:63]
    buffer_load_dwordx4 v[252:255], v8, s[36:39], s12 offen offset:1024 sc1
    v_mfma_f32_16x16x32_bf16 v[72:75], v[172:175], a[104:107], v[72:75]
    v_fmamk_f32 v170, v165, 0x40000000, v166
    v_mfma_f32_16x16x32_bf16 v[80:83], v[172:175], a[168:171], v[80:83]
    v_fmamk_f32 v171, v165, 0x40400000, v166
    v_mfma_f32_16x16x32_bf16 v[88:91], v[172:175], a[232:235], v[88:91]
    v_cos_f32 v124, v168
    v_mfma_f32_16x16x32_bf16 v[64:67], v[172:175], a[40:43], v[64:67]
    buffer_load_dwordx4 v[172:175], v8, s[36:39], s13 offen offset:0 sc1
    s_waitcnt vmcnt(26)
    v_mfma_f32_16x16x32_bf16 v[68:71], v[176:179], a[108:111], v[68:71]
    v_sin_f32 v168, v168
    v_mfma_f32_16x16x32_bf16 v[76:79], v[176:179], a[172:175], v[76:79]
    v_cos_f32 v125, v169
    v_mfma_f32_16x16x32_bf16 v[84:87], v[176:179], a[236:239], v[84:87]
    v_sin_f32 v169, v169
    v_mfma_f32_16x16x32_bf16 v[60:63], v[176:179], a[44:47], v[60:63]
    buffer_load_dwordx4 v[176:179], v8, s[36:39], s13 offen offset:1024 sc1
    v_mfma_f32_16x16x32_bf16 v[72:75], v[180:183], a[108:111], v[72:75]
    v_cos_f32 v126, v170
    v_mfma_f32_16x16x32_bf16 v[80:83], v[180:183], a[172:175], v[80:83]
    v_sin_f32 v170, v170
    v_mfma_f32_16x16x32_bf16 v[88:91], v[180:183], a[236:239], v[88:91]
    v_cos_f32 v127, v171
    v_mfma_f32_16x16x32_bf16 v[64:67], v[180:183], a[44:47], v[64:67]
    buffer_load_dwordx4 v[180:183], v8, s[36:39], s14 offen offset:0 sc1
    s_waitcnt vmcnt(25)
    v_mfma_f32_16x16x32_bf16 v[68:71], v[184:187], a[112:115], v[68:71]
    v_sin_f32 v171, v171
    v_mfma_f32_16x16x32_bf16 v[76:79], v[184:187], a[176:179], v[76:79]
    v_cvt_pk_bf16_f32 v124, v124, v168
    v_mfma_f32_16x16x32_bf16 v[84:87], v[184:187], a[240:243], v[84:87]
    v_cvt_pk_bf16_f32 v125, v125, v169
    v_mfma_f32_16x16x32_bf16 v[60:63], v[184:187], a[48:51], v[60:63]
    buffer_load_dwordx4 v[184:187], v8, s[36:39], s14 offen offset:1024 sc1
    v_mfma_f32_16x16x32_bf16 v[72:75], v[188:191], a[112:115], v[72:75]
    v_cvt_pk_bf16_f32 v126, v126, v170
    v_mfma_f32_16x16x32_bf16 v[80:83], v[188:191], a[176:179], v[80:83]
    v_cvt_pk_bf16_f32 v127, v127, v171
    s_add_u32 m0, s6, 16384
    s_add_u32 s87, s97, 98304
    buffer_load_dwordx4 v9, s[28:31], s87 offen lds
    v_mfma_f32_16x16x32_bf16 v[88:91], v[188:191], a[240:243], v[88:91]
    v_fmamk_f32 v168, v165, 0x41800000, v166
    v_mfma_f32_16x16x32_bf16 v[64:67], v[188:191], a[48:51], v[64:67]
    buffer_load_dwordx4 v[188:191], v8, s[36:39], s15 offen offset:0 sc1
    s_waitcnt vmcnt(24)
    v_mfma_f32_16x16x32_bf16 v[68:71], v[192:195], a[116:119], v[68:71]
    v_fmamk_f32 v169, v165, 0x41880000, v166
    v_mfma_f32_16x16x32_bf16 v[76:79], v[192:195], a[180:183], v[76:79]
    v_fmamk_f32 v170, v165, 0x41900000, v166
    v_mfma_f32_16x16x32_bf16 v[84:87], v[192:195], a[244:247], v[84:87]
    v_fmamk_f32 v171, v165, 0x41980000, v166
    v_mfma_f32_16x16x32_bf16 v[60:63], v[192:195], a[52:55], v[60:63]
    buffer_load_dwordx4 v[192:195], v8, s[36:39], s15 offen offset:1024 sc1
    v_mfma_f32_16x16x32_bf16 v[72:75], v[196:199], a[116:119], v[72:75]
    v_cos_f32 v128, v168
    v_mfma_f32_16x16x32_bf16 v[80:83], v[196:199], a[180:183], v[80:83]
    v_sin_f32 v168, v168
    v_mfma_f32_16x16x32_bf16 v[88:91], v[196:199], a[244:247], v[88:91]
    v_cos_f32 v129, v169
    v_mfma_f32_16x16x32_bf16 v[64:67], v[196:199], a[52:55], v[64:67]
    buffer_load_dwordx4 v[196:199], v8, s[36:39], s16 offen offset:0 sc1
    s_waitcnt vmcnt(24)
    v_mfma_f32_16x16x32_bf16 v[68:71], v[200:203], a[120:123], v[68:71]
    v_sin_f32 v169, v169
    v_mfma_f32_16x16x32_bf16 v[76:79], v[200:203], a[184:187], v[76:79]
    v_cos_f32 v130, v170
    v_mfma_f32_16x16x32_bf16 v[84:87], v[200:203], a[248:251], v[84:87]
    v_sin_f32 v170, v170
    v_mfma_f32_16x16x32_bf16 v[60:63], v[200:203], a[56:59], v[60:63]
    buffer_load_dwordx4 v[200:203], v8, s[36:39], s16 offen offset:1024 sc1
    v_mfma_f32_16x16x32_bf16 v[72:75], v[204:207], a[120:123], v[72:75]
    v_cos_f32 v131, v171
    v_mfma_f32_16x16x32_bf16 v[80:83], v[204:207], a[184:187], v[80:83]
    v_sin_f32 v171, v171
    v_mfma_f32_16x16x32_bf16 v[88:91], v[204:207], a[248:251], v[88:91]
    v_cvt_pk_bf16_f32 v128, v128, v168
    v_mfma_f32_16x16x32_bf16 v[64:67], v[204:207], a[56:59], v[64:67]
    buffer_load_dwordx4 v[204:207], v8, s[36:39], s17 offen offset:0 sc1
    s_waitcnt vmcnt(22)
    v_mfma_f32_16x16x32_bf16 v[68:71], v[208:211], a[124:127], v[68:71]
    v_cvt_pk_bf16_f32 v129, v129, v169
    v_mfma_f32_16x16x32_bf16 v[76:79], v[208:211], a[188:191], v[76:79]
    v_cvt_pk_bf16_f32 v130, v130, v170
    s_add_u32 s87, s97, 204800
    buffer_load_dwordx4 v13, s[28:31], s87 offen offset:1024 lds
    v_mfma_f32_16x16x32_bf16 v[84:87], v[208:211], a[252:255], v[84:87]
    v_cvt_pk_bf16_f32 v131, v131, v171
    v_mfma_f32_16x16x32_bf16 v[60:63], v[208:211], a[60:63], v[60:63]
    buffer_load_dwordx4 v[208:211], v8, s[36:39], s17 offen offset:1024 sc1
    v_mfma_f32_16x16x32_bf16 v[72:75], v[212:215], a[124:127], v[72:75]
    v_fmamk_f32 v168, v165, 0x42000000, v166
    v_mfma_f32_16x16x32_bf16 v[80:83], v[212:215], a[188:191], v[80:83]
    v_fmamk_f32 v169, v165, 0x42040000, v166
    v_mfma_f32_16x16x32_bf16 v[88:91], v[212:215], a[252:255], v[88:91]
    v_fmamk_f32 v170, v165, 0x42080000, v166
    v_mfma_f32_16x16x32_bf16 v[64:67], v[212:215], a[60:63], v[64:67]
    buffer_load_dwordx4 v[212:215], v8, s[36:39], s18 offen offset:0 sc1
    s_waitcnt vmcnt(23)
    v_mfma_f32_16x16x32_bf16 v[100:103], v[216:219], a[64:67], 0
    ds_write_b128 v10, v[68:71] offset:32768
    v_mfma_f32_16x16x32_bf16 v[108:111], v[216:219], a[128:131], 0
    v_fmamk_f32 v171, v165, 0x420c0000, v166
    v_mfma_f32_16x16x32_bf16 v[116:119], v[216:219], a[192:195], 0
    v_cos_f32 v132, v168
    v_mfma_f32_16x16x32_bf16 v[92:95], v[216:219], a[0:3], v[156:159]
    buffer_load_dwordx4 v[216:219], v8, s[36:39], s18 offen offset:1024 sc1
    v_mfma_f32_16x16x32_bf16 v[104:107], v[220:223], a[64:67], 0
    ds_write_b128 v10, v[72:75] offset:33792
    v_mfma_f32_16x16x32_bf16 v[112:115], v[220:223], a[128:131], 0
    v_sin_f32 v168, v168
    v_mfma_f32_16x16x32_bf16 v[120:123], v[220:223], a[192:195], 0
    v_cos_f32 v133, v169
    v_mfma_f32_16x16x32_bf16 v[96:99], v[220:223], a[0:3], v[156:159]
    buffer_load_dwordx4 v[220:223], v8, s[36:39], s19 offen offset:0 sc1
    s_waitcnt vmcnt(23)
    v_mfma_f32_16x16x32_bf16 v[100:103], v[224:227], a[68:71], v[100:103]
    ds_write_b128 v28, v[76:79] offset:34816
    v_mfma_f32_16x16x32_bf16 v[108:111], v[224:227], a[132:135], v[108:111]
    v_sin_f32 v169, v169
    v_mfma_f32_16x16x32_bf16 v[116:119], v[224:227], a[196:199], v[116:119]
    v_cos_f32 v134, v170
    v_mfma_f32_16x16x32_bf16 v[92:95], v[224:227], a[4:7], v[92:95]
    buffer_load_dwordx4 v[224:227], v8, s[36:39], s19 offen offset:1024 sc1
    v_mfma_f32_16x16x32_bf16 v[104:107], v[228:231], a[68:71], v[104:107]
    ds_write_b128 v28, v[80:83] offset:35840
    v_mfma_f32_16x16x32_bf16 v[112:115], v[228:231], a[132:135], v[112:115]
    v_sin_f32 v170, v170
    s_add_u32 s87, s97, 90112
    buffer_load_dwordx4 v26, s[28:31], s87 offen offset:2048 lds
    v_mfma_f32_16x16x32_bf16 v[120:123], v[228:231], a[196:199], v[120:123]
    v_cos_f32 v135, v171
    v_mfma_f32_16x16x32_bf16 v[96:99], v[228:231], a[4:7], v[96:99]
    buffer_load_dwordx4 v[228:231], v8, s[36:39], s20 offen offset:0 sc1
    s_waitcnt vmcnt(23)
    v_mfma_f32_16x16x32_bf16 v[100:103], v[232:235], a[72:75], v[100:103]
    ds_write_b128 v29, v[84:87] offset:36864
    v_mfma_f32_16x16x32_bf16 v[108:111], v[232:235], a[136:139], v[108:111]
    v_sin_f32 v171, v171
    v_mfma_f32_16x16x32_bf16 v[116:119], v[232:235], a[200:203], v[116:119]
    v_cvt_pk_bf16_f32 v132, v132, v168
    v_mfma_f32_16x16x32_bf16 v[92:95], v[232:235], a[8:11], v[92:95]
    buffer_load_dwordx4 v[232:235], v8, s[36:39], s20 offen offset:1024 sc1
    v_mfma_f32_16x16x32_bf16 v[104:107], v[236:239], a[72:75], v[104:107]
    ds_write_b128 v29, v[88:91] offset:37888
    v_mfma_f32_16x16x32_bf16 v[112:115], v[236:239], a[136:139], v[112:115]
    v_cvt_pk_bf16_f32 v133, v133, v169
    v_mfma_f32_16x16x32_bf16 v[120:123], v[236:239], a[200:203], v[120:123]
    v_cvt_pk_bf16_f32 v134, v134, v170
    v_mfma_f32_16x16x32_bf16 v[96:99], v[236:239], a[8:11], v[96:99]
    buffer_load_dwordx4 v[236:239], v8, s[36:39], s21 offen offset:0 sc1
    s_waitcnt vmcnt(23)
    v_mfma_f32_16x16x32_bf16 v[100:103], v[240:243], a[76:79], v[100:103]
    v_cvt_pk_bf16_f32 v135, v135, v171
    v_mfma_f32_16x16x32_bf16 v[108:111], v[240:243], a[140:143], v[108:111]
    v_fmamk_f32 v168, v165, 0x42400000, v166
    v_mfma_f32_16x16x32_bf16 v[116:119], v[240:243], a[204:207], v[116:119]
    v_fmamk_f32 v169, v165, 0x42440000, v166
    v_mfma_f32_16x16x32_bf16 v[92:95], v[240:243], a[12:15], v[92:95]
    buffer_load_dwordx4 v[240:243], v8, s[36:39], s21 offen offset:1024 sc1
    v_mfma_f32_16x16x32_bf16 v[104:107], v[244:247], a[76:79], v[104:107]
    s_waitcnt vmcnt(36) lgkmcnt(0)
    s_barrier
    s_lshl_b32 s76, s2, 3
    s_add_u32 s76, s76, 13238272
    s_cmp_eq_u32 s54, 0
    s_cselect_b32 s76, s76, 16777216
    v_mov_b32 v18, s56
    v_mov_b32 v19, s57
    s_mov_b64 exec, 1
    buffer_store_dwordx2 v[18:19], off, s[36:39], s76 sc1
    s_mov_b64 exec, -1
    v_mfma_f32_16x16x32_bf16 v[112:115], v[244:247], a[140:143], v[112:115]
    ds_read_b128 v[68:71], v2 offset:32768
    v_mfma_f32_16x16x32_bf16 v[120:123], v[244:247], a[204:207], v[120:123]
    ds_read_b128 v[72:75], v2 offset:33792
    v_mfma_f32_16x16x32_bf16 v[96:99], v[244:247], a[12:15], v[96:99]
    buffer_load_dwordx4 v[244:247], v8, s[36:39], s22 offen offset:0 sc1
    s_waitcnt vmcnt(23)
    v_mfma_f32_16x16x32_bf16 v[100:103], v[248:251], a[80:83], v[100:103]
    ds_read_b128 v[76:79], v2 offset:34816
    v_mfma_f32_16x16x32_bf16 v[108:111], v[248:251], a[144:147], v[108:111]
    ds_read_b128 v[80:83], v2 offset:35840
    s_add_u32 s87, s97, 196608
    buffer_load_dwordx4 v27, s[28:31], s87 offen offset:3072 lds
    v_mfma_f32_16x16x32_bf16 v[116:119], v[248:251], a[208:211], v[116:119]
    ds_read_b128 v[84:87], v2 offset:36864
    v_mfma_f32_16x16x32_bf16 v[92:95], v[248:251], a[16:19], v[92:95]
    buffer_load_dwordx4 v[248:251], v8, s[36:39], s22 offen offset:1024 sc1
    v_mfma_f32_16x16x32_bf16 v[104:107], v[252:255], a[80:83], v[104:107]
    ds_read_b128 v[88:91], v2 offset:37888
    v_mfma_f32_16x16x32_bf16 v[112:115], v[252:255], a[144:147], v[112:115]
    v_fmamk_f32 v170, v165, 0x42480000, v166
    v_mfma_f32_16x16x32_bf16 v[120:123], v[252:255], a[208:211], v[120:123]
    v_fmamk_f32 v171, v165, 0x424c0000, v166
    v_mfma_f32_16x16x32_bf16 v[96:99], v[252:255], a[16:19], v[96:99]
    buffer_load_dwordx4 v[252:255], v8, s[36:39], s23 offen offset:0 sc1
    s_waitcnt vmcnt(24)
    v_mfma_f32_16x16x32_bf16 v[100:103], v[172:175], a[84:87], v[100:103]
    v_cos_f32 v136, v168
    v_mfma_f32_16x16x32_bf16 v[108:111], v[172:175], a[148:151], v[108:111]
    v_sin_f32 v168, v168
    v_mfma_f32_16x16x32_bf16 v[116:119], v[172:175], a[212:215], v[116:119]
    s_waitcnt lgkmcnt(0)
    s_barrier
    v_mfma_f32_16x16x32_bf16 v[92:95], v[172:175], a[20:23], v[92:95]
    buffer_load_dwordx4 v[172:175], v8, s[36:39], s23 offen offset:1024 sc1
    v_mfma_f32_16x16x32_bf16 v[104:107], v[176:179], a[84:87], v[104:107]
    v_mfma_f32_16x16x32_bf16 v[112:115], v[176:179], a[148:151], v[112:115]
    v_add_f32 v60, v60, v68
    v_mfma_f32_16x16x32_bf16 v[120:123], v[176:179], a[212:215], v[120:123]
    v_add_f32 v61, v61, v69
    v_mfma_f32_16x16x32_bf16 v[96:99], v[176:179], a[20:23], v[96:99]
    v_add_u32 v8, 32768, v8
    buffer_load_dwordx4 v[176:179], v8, s[36:39], s8 offen offset:0 sc1
    s_waitcnt vmcnt(24)
    v_mfma_f32_16x16x32_bf16 v[100:103], v[180:183], a[88:91], v[100:103]
    v_add_f32 v62, v62, v70
    v_mfma_f32_16x16x32_bf16 v[108:111], v[180:183], a[152:155], v[108:111]
    v_add_f32 v63, v63, v71
    v_mfma_f32_16x16x32_bf16 v[116:119], v[180:183], a[216:219], v[116:119]
    v_add_f32 v64, v64, v72
    v_mfma_f32_16x16x32_bf16 v[92:95], v[180:183], a[24:27], v[92:95]
    buffer_load_dwordx4 v[180:183], v8, s[36:39], s8 offen offset:1024 sc1
    v_mfma_f32_16x16x32_bf16 v[104:107], v[184:187], a[88:91], v[104:107]
    v_add_f32 v65, v65, v73
    v_mfma_f32_16x16x32_bf16 v[112:115], v[184:187], a[152:155], v[112:115]
    v_add_f32 v66, v66, v74
    v_mfma_f32_16x16x32_bf16 v[120:123], v[184:187], a[216:219], v[120:123]
    v_add_f32 v67, v67, v75
    v_mfma_f32_16x16x32_bf16 v[96:99], v[184:187], a[24:27], v[96:99]
    buffer_load_dwordx4 v[184:187], v8, s[36:39], s9 offen offset:0 sc1
    s_waitcnt vmcnt(23)
    v_mfma_f32_16x16x32_bf16 v[100:103], v[188:191], a[92:95], v[100:103]
    v_mfma_f32_16x16x32_bf16 v[108:111], v[188:191], a[156:159], v[108:111]
    v_add_f32 v60, v60, v76
    v_mfma_f32_16x16x32_bf16 v[116:119], v[188:191], a[220:223], v[116:119]
    v_add_f32 v61, v61, v77
    v_mfma_f32_16x16x32_bf16 v[92:95], v[188:191], a[28:31], v[92:95]
    buffer_load_dwordx4 v[188:191], v8, s[36:39], s9 offen offset:1024 sc1
    v_mfma_f32_16x16x32_bf16 v[104:107], v[192:195], a[92:95], v[104:107]
    v_add_f32 v62, v62, v78
    v_mfma_f32_16x16x32_bf16 v[112:115], v[192:195], a[156:159], v[112:115]
    v_add_f32 v63, v63, v79
    v_mfma_f32_16x16x32_bf16 v[120:123], v[192:195], a[220:223], v[120:123]
    v_add_f32 v64, v64, v80
    v_mfma_f32_16x16x32_bf16 v[96:99], v[192:195], a[28:31], v[96:99]
    buffer_load_dwordx4 v[192:195], v8, s[36:39], s10 offen offset:0 sc1
    s_waitcnt vmcnt(23)
    v_mfma_f32_16x16x32_bf16 v[100:103], v[196:199], a[96:99], v[100:103]
    v_add_f32 v65, v65, v81
    v_mfma_f32_16x16x32_bf16 v[108:111], v[196:199], a[160:163], v[108:111]
    v_add_f32 v66, v66, v82
    v_mfma_f32_16x16x32_bf16 v[116:119], v[196:199], a[224:227], v[116:119]
    v_add_f32 v67, v67, v83
    v_mfma_f32_16x16x32_bf16 v[92:95], v[196:199], a[32:35], v[92:95]
    buffer_load_dwordx4 v[196:199], v8, s[36:39], s10 offen offset:1024 sc1
    v_mfma_f32_16x16x32_bf16 v[104:107], v[200:203], a[96:99], v[104:107]
    v_mfma_f32_16x16x32_bf16 v[112:115], v[200:203], a[160:163], v[112:115]
    v_add_f32 v60, v60, v84
    v_mfma_f32_16x16x32_bf16 v[120:123], v[200:203], a[224:227], v[120:123]
    v_add_f32 v61, v61, v85
    v_mfma_f32_16x16x32_bf16 v[96:99], v[200:203], a[32:35], v[96:99]
    buffer_load_dwordx4 v[200:203], v8, s[36:39], s11 offen offset:0 sc1
    s_waitcnt vmcnt(22)
    v_mfma_f32_16x16x32_bf16 v[100:103], v[204:207], a[100:103], v[100:103]
    v_add_f32 v62, v62, v86
    v_mfma_f32_16x16x32_bf16 v[108:111], v[204:207], a[164:167], v[108:111]
    v_add_f32 v63, v63, v87
    v_mfma_f32_16x16x32_bf16 v[116:119], v[204:207], a[228:231], v[116:119]
    v_add_f32 v64, v64, v88
    v_mfma_f32_16x16x32_bf16 v[92:95], v[204:207], a[36:39], v[92:95]
    buffer_load_dwordx4 v[204:207], v8, s[36:39], s11 offen offset:1024 sc1
    v_mfma_f32_16x16x32_bf16 v[104:107], v[208:211], a[100:103], v[104:107]
    v_add_f32 v65, v65, v89
    v_mfma_f32_16x16x32_bf16 v[112:115], v[208:211], a[164:167], v[112:115]
    v_add_f32 v66, v66, v90
    v_mfma_f32_16x16x32_bf16 v[120:123], v[208:211], a[228:231], v[120:123]
    v_add_f32 v67, v67, v91
    v_mfma_f32_16x16x32_bf16 v[96:99], v[208:211], a[36:39], v[96:99]
    buffer_load_dwordx4 v[208:211], v8, s[36:39], s12 offen offset:0 sc1
    s_waitcnt vmcnt(22)
    v_mfma_f32_16x16x32_bf16 v[100:103], v[212:215], a[104:107], v[100:103]
    v_mul_f32 v60, v60, v32
    v_mfma_f32_16x16x32_bf16 v[108:111], v[212:215], a[168:171], v[108:111]
    v_mul_f32 v61, v61, v33
    v_mfma_f32_16x16x32_bf16 v[116:119], v[212:215], a[232:235], v[116:119]
    v_mul_f32 v62, v62, v34
    v_mfma_f32_16x16x32_bf16 v[92:95], v[212:215], a[40:43], v[92:95]
    buffer_load_dwordx4 v[212:215], v8, s[36:39], s12 offen offset:1024 sc1
    v_mfma_f32_16x16x32_bf16 v[104:107], v[216:219], a[104:107], v[104:107]
    v_mul_f32 v63, v63, v35
    v_mfma_f32_16x16x32_bf16 v[112:115], v[216:219], a[168:171], v[112:115]
    v_mul_f32 v64, v64, v36
    v_mfma_f32_16x16x32_bf16 v[120:123], v[216:219], a[232:235], v[120:123]
    v_mul_f32 v65, v65, v37
    v_mfma_f32_16x16x32_bf16 v[96:99], v[216:219], a[40:43], v[96:99]
    buffer_load_dwordx4 v[216:219], v8, s[36:39], s13 offen offset:0 sc1
    s_waitcnt vmcnt(22)
    v_mfma_f32_16x16x32_bf16 v[100:103], v[220:223], a[108:111], v[100:103]
    v_mul_f32 v66, v66, v38
    v_mfma_f32_16x16x32_bf16 v[108:111], v[220:223], a[172:175], v[108:111]
    v_mul_f32 v67, v67, v39
    v_mfma_f32_16x16x32_bf16 v[116:119], v[220:223], a[236:239], v[116:119]
    v_cvt_pk_bf16_f32 v160, v60, v61
    v_mfma_f32_16x16x32_bf16 v[92:95], v[220:223], a[44:47], v[92:95]
    buffer_load_dwordx4 v[220:223], v8, s[36:39], s13 offen offset:1024 sc1
    v_mfma_f32_16x16x32_bf16 v[104:107], v[224:227], a[108:111], v[104:107]
    v_cvt_pk_bf16_f32 v161, v62, v63
    v_mfma_f32_16x16x32_bf16 v[112:115], v[224:227], a[172:175], v[112:115]
    v_cvt_pk_bf16_f32 v162, v64, v65
    v_mfma_f32_16x16x32_bf16 v[120:123], v[224:227], a[236:239], v[120:123]
    v_cvt_pk_bf16_f32 v163, v66, v67
    v_mfma_f32_16x16x32_bf16 v[96:99], v[224:227], a[44:47], v[96:99]
    buffer_load_dwordx4 v[224:227], v8, s[36:39], s14 offen offset:0 sc1
    s_waitcnt vmcnt(21)
    v_mfma_f32_16x16x32_bf16 v[100:103], v[228:231], a[112:115], v[100:103]
    v_min_u32 v160, -2, v160
    v_mfma_f32_16x16x32_bf16 v[108:111], v[228:231], a[176:179], v[108:111]
    v_min_u32 v161, -2, v161
    v_mfma_f32_16x16x32_bf16 v[116:119], v[228:231], a[240:243], v[116:119]
    v_min_u32 v162, -2, v162
    v_mfma_f32_16x16x32_bf16 v[92:95], v[228:231], a[48:51], v[92:95]
    buffer_load_dwordx4 v[228:231], v8, s[36:39], s14 offen offset:1024 sc1
    v_mfma_f32_16x16x32_bf16 v[104:107], v[232:235], a[112:115], v[104:107]
    v_min_u32 v163, -2, v163
    v_mfma_f32_16x16x32_bf16 v[112:115], v[232:235], a[176:179], v[112:115]
    s_add_u32 s76, s85, 0
    buffer_store_dwordx4 v[160:163], v1, s[36:39], s76 offen sc1
    v_mfma_f32_16x16x32_bf16 v[120:123], v[232:235], a[240:243], v[120:123]
    v_cos_f32 v137, v169
    v_mfma_f32_16x16x32_bf16 v[96:99], v[232:235], a[48:51], v[96:99]
    buffer_load_dwordx4 v[232:235], v8, s[36:39], s15 offen offset:0 sc1
    s_waitcnt vmcnt(22)
    v_mfma_f32_16x16x32_bf16 v[100:103], v[236:239], a[116:119], v[100:103]
    v_sin_f32 v169, v169
    v_mfma_f32_16x16x32_bf16 v[108:111], v[236:239], a[180:183], v[108:111]
    v_cos_f32 v138, v170
    v_mfma_f32_16x16x32_bf16 v[116:119], v[236:239], a[244:247], v[116:119]
    v_sin_f32 v170, v170
    v_mfma_f32_16x16x32_bf16 v[92:95], v[236:239], a[52:55], v[92:95]
    buffer_load_dwordx4 v[236:239], v8, s[36:39], s15 offen offset:1024 sc1
    v_mfma_f32_16x16x32_bf16 v[104:107], v[240:243], a[116:119], v[104:107]
    v_cos_f32 v139, v171
    v_mfma_f32_16x16x32_bf16 v[112:115], v[240:243], a[180:183], v[112:115]
    v_sin_f32 v171, v171
    v_mfma_f32_16x16x32_bf16 v[120:123], v[240:243], a[244:247], v[120:123]
    v_cvt_pk_bf16_f32 v136, v136, v168
    v_mfma_f32_16x16x32_bf16 v[96:99], v[240:243], a[52:55], v[96:99]
    buffer_load_dwordx4 v[240:243], v8, s[36:39], s16 offen offset:0 sc1
    s_waitcnt vmcnt(20)
    v_mfma_f32_16x16x32_bf16 v[100:103], v[244:247], a[120:123], v[100:103]
    v_cvt_pk_bf16_f32 v137, v137, v169
    v_mfma_f32_16x16x32_bf16 v[108:111], v[244:247], a[184:187], v[108:111]
    v_cvt_pk_bf16_f32 v138, v138, v170
    v_mfma_f32_16x16x32_bf16 v[116:119], v[244:247], a[248:251], v[116:119]
    v_cvt_pk_bf16_f32 v139, v139, v171
    v_mfma_f32_16x16x32_bf16 v[92:95], v[244:247], a[56:59], v[92:95]
    buffer_load_dwordx4 v[244:247], v8, s[36:39], s16 offen offset:1024 sc1
    v_mfma_f32_16x16x32_bf16 v[104:107], v[248:251], a[120:123], v[104:107]
    v_lshl_add_u32 v165, v3, 7, s45
    v_mfma_f32_16x16x32_bf16 v[112:115], v[248:251], a[184:187], v[112:115]
    v_cvt_f32_u32 v165, v165
    v_mfma_f32_16x16x32_bf16 v[120:123], v[248:251], a[248:251], v[120:123]
    v_mul_f32 v165, 0x3a000000, v165
    v_mfma_f32_16x16x32_bf16 v[96:99], v[248:251], a[56:59], v[96:99]
    buffer_load_dwordx4 v[248:251], v8, s[36:39], s17 offen offset:0 sc1
    s_waitcnt vmcnt(20)
    v_mfma_f32_16x16x32_bf16 v[100:103], v[252:255], a[124:127], v[100:103]
    v_xor_b32 v165, s4, v165
    v_mfma_f32_16x16x32_bf16 v[108:111], v[252:255], a[188:191], v[108:111]
    v_mul_f32 v166, v164, v165
    v_mfma_f32_16x16x32_bf16 v[116:119], v[252:255], a[252:255], v[116:119]
    v_fmamk_f32 v168, v165, 0x00000000, v166
    v_mfma_f32_16x16x32_bf16 v[92:95], v[252:255], a[60:63], v[92:95]
    buffer_load_dwordx4 v[252:255], v8, s[36:39], s17 offen offset:1024 sc1
    v_mfma_f32_16x16x32_bf16 v[104:107], v[172:175], a[124:127], v[104:107]
    v_fmamk_f32 v169, v165, 0x3f800000, v166
    v_mfma_f32_16x16x32_bf16 v[112:115], v[172:175], a[188:191], v[112:115]
    v_fmamk_f32 v170, v165, 0x40000000, v166
    v_mfma_f32_16x16x32_bf16 v[120:123], v[172:175], a[252:255], v[120:123]
    v_fmamk_f32 v171, v165, 0x40400000, v166
    v_mfma_f32_16x16x32_bf16 v[96:99], v[172:175], a[60:63], v[96:99]
    buffer_load_dwordx4 v[172:175], v8, s[36:39], s18 offen offset:0 sc1
    s_waitcnt vmcnt(20)
    v_mfma_f32_16x16x32_bf16 v[68:71], v[176:179], a[64:67], 0
    ds_write_b128 v10, v[100:103] offset:32768
    v_mfma_f32_16x16x32_bf16 v[76:79], v[176:179], a[128:131], 0
    v_cos_f32 v140, v168
    v_mfma_f32_16x16x32_bf16 v[84:87], v[176:179], a[192:195], 0
    v_sin_f32 v168, v168
    v_mfma_f32_16x16x32_bf16 v[60:63], v[176:179], a[0:3], v[156:159]
    buffer_load_dwordx4 v[176:179], v8, s[36:39], s18 offen offset:1024 sc1
    v_mfma_f32_16x16x32_bf16 v[72:75], v[180:183], a[64:67], 0
    ds_write_b128 v10, v[104:107] offset:33792
    v_mfma_f32_16x16x32_bf16 v[80:83], v[180:183], a[128:131], 0
    v_cos_f32 v141, v169
    v_mfma_f32_16x16x32_bf16 v[88:91], v[180:183], a[192:195], 0
    v_sin_f32 v169, v169
    v_mfma_f32_16x16x32_bf16 v[64:67], v[180:183], a[0:3], v[156:159]
    buffer_load_dwordx4 v[180:183], v8, s[36:39], s19 offen offset:0 sc1
    s_waitcnt vmcnt(20)
    v_mfma_f32_16x16x32_bf16 v[68:71], v[184:187], a[68:71], v[68:71]
    ds_write_b128 v28, v[108:111] offset:34816
    v_mfma_f32_16x16x32_bf16 v[76:79], v[184:187], a[132:135], v[76:79]
    v_cos_f32 v142, v170
    v_mfma_f32_16x16x32_bf16 v[84:87], v[184:187], a[196:199], v[84:87]
    v_sin_f32 v170, v170
    v_mfma_f32_16x16x32_bf16 v[60:63], v[184:187], a[4:7], v[60:63]
    buffer_load_dwordx4 v[184:187], v8, s[36:39], s19 offen offset:1024 sc1
    v_mfma_f32_16x16x32_bf16 v[72:75], v[188:191], a[68:71], v[72:75]
    ds_write_b128 v28, v[112:115] offset:35840
    v_mfma_f32_16x16x32_bf16 v[80:83], v[188:191], a[132:135], v[80:83]
    v_cos_f32 v143, v171
    v_mfma_f32_16x16x32_bf16 v[88:91], v[188:191], a[196:199], v[88:91]
    v_sin_f32 v171, v171
    v_mfma_f32_16x16x32_bf16 v[64:67], v[188:191], a[4:7], v[64:67]
    buffer_load_dwordx4 v[188:191], v8, s[36:39], s20 offen offset:0 sc1
    s_waitcnt vmcnt(20)
    v_mfma_f32_16x16x32_bf16 v[68:71], v[192:195], a[72:75], v[68:71]
    ds_write_b128 v29, v[116:119] offset:36864
    v_mfma_f32_16x16x32_bf16 v[76:79], v[192:195], a[136:139], v[76:79]
    v_cvt_pk_bf16_f32 v140, v140, v168
    v_mfma_f32_16x16x32_bf16 v[84:87], v[192:195], a[200:203], v[84:87]
    v_cvt_pk_bf16_f32 v141, v141, v169
    v_mfma_f32_16x16x32_bf16 v[60:63], v[192:195], a[8:11], v[60:63]
    buffer_load_dwordx4 v[192:195], v8, s[36:39], s20 offen offset:1024 sc1
    v_mfma_f32_16x16x32_bf16 v[72:75], v[196:199], a[72:75], v[72:75]
    ds_write_b128 v29, v[120:123] offset:37888
    v_mfma_f32_16x16x32_bf16 v[80:83], v[196:199], a[136:139], v[80:83]
    v_cvt_pk_bf16_f32 v142, v142, v170
    v_mfma_f32_16x16x32_bf16 v[88:91], v[196:199], a[200:203], v[88:91]
    v_cvt_pk_bf16_f32 v143, v143, v171
    v_mfma_f32_16x16x32_bf16 v[64:67], v[196:199], a[8:11], v[64:67]
    buffer_load_dwordx4 v[196:199], v8, s[36:39], s21 offen offset:0 sc1
    s_waitcnt vmcnt(20)
    v_mfma_f32_16x16x32_bf16 v[68:71], v[200:203], a[76:79], v[68:71]
    v_fmamk_f32 v168, v165, 0x41800000, v166
    v_mfma_f32_16x16x32_bf16 v[76:79], v[200:203], a[140:143], v[76:79]
    v_fmamk_f32 v169, v165, 0x41880000, v166
    v_mfma_f32_16x16x32_bf16 v[84:87], v[200:203], a[204:207], v[84:87]
    v_fmamk_f32 v170, v165, 0x41900000, v166
    v_mfma_f32_16x16x32_bf16 v[60:63], v[200:203], a[12:15], v[60:63]
    buffer_load_dwordx4 v[200:203], v8, s[36:39], s21 offen offset:1024 sc1
    v_mfma_f32_16x16x32_bf16 v[72:75], v[204:207], a[76:79], v[72:75]
    s_waitcnt lgkmcnt(0)
    s_barrier
    v_mfma_f32_16x16x32_bf16 v[80:83], v[204:207], a[140:143], v[80:83]
    ds_read_b128 v[100:103], v2 offset:32768
    v_mfma_f32_16x16x32_bf16 v[88:91], v[204:207], a[204:207], v[88:91]
    ds_read_b128 v[104:107], v2 offset:33792
    v_mfma_f32_16x16x32_bf16 v[64:67], v[204:207], a[12:15], v[64:67]
    buffer_load_dwordx4 v[204:207], v8, s[36:39], s22 offen offset:0 sc1
    s_waitcnt vmcnt(20)
    v_mfma_f32_16x16x32_bf16 v[68:71], v[208:211], a[80:83], v[68:71]
    ds_read_b128 v[108:111], v2 offset:34816
    v_mfma_f32_16x16x32_bf16 v[76:79], v[208:211], a[144:147], v[76:79]
    ds_read_b128 v[112:115], v2 offset:35840
    v_mfma_f32_16x16x32_bf16 v[84:87], v[208:211], a[208:211], v[84:87]
    ds_read_b128 v[116:119], v2 offset:36864
    v_mfma_f32_16x16x32_bf16 v[60:63], v[208:211], a[16:19], v[60:63]
    buffer_load_dwordx4 v[208:211], v8, s[36:39], s22 offen offset:1024 sc1
    v_mfma_f32_16x16x32_bf16 v[72:75], v[212:215], a[80:83], v[72:75]
    ds_read_b128 v[120:123], v2 offset:37888
    v_mfma_f32_16x16x32_bf16 v[80:83], v[212:215], a[144:147], v[80:83]
    v_fmamk_f32 v171, v165, 0x41980000, v166
    v_mfma_f32_16x16x32_bf16 v[88:91], v[212:215], a[208:211], v[88:91]
    v_cos_f32 v144, v168
    v_mfma_f32_16x16x32_bf16 v[64:67], v[212:215], a[16:19], v[64:67]
    buffer_load_dwordx4 v[212:215], v8, s[36:39], s23 offen offset:0 sc1
    s_waitcnt vmcnt(20)
    v_mfma_f32_16x16x32_bf16 v[68:71], v[216:219], a[84:87], v[68:71]
    v_sin_f32 v168, v168
    v_mfma_f32_16x16x32_bf16 v[76:79], v[216:219], a[148:151], v[76:79]
    v_cos_f32 v145, v169
    v_mfma_f32_16x16x32_bf16 v[84:87], v[216:219], a[212:215], v[84:87]
    s_waitcnt lgkmcnt(0)
    s_barrier
    v_mfma_f32_16x16x32_bf16 v[60:63], v[216:219], a[20:23], v[60:63]
    buffer_load_dwordx4 v[216:219], v8, s[36:39], s23 offen offset:1024 sc1
    v_mfma_f32_16x16x32_bf16 v[72:75], v[220:223], a[84:87], v[72:75]
    v_mfma_f32_16x16x32_bf16 v[80:83], v[220:223], a[148:151], v[80:83]
    v_add_f32 v92, v92, v100
    v_mfma_f32_16x16x32_bf16 v[88:91], v[220:223], a[212:215], v[88:91]
    v_add_f32 v93, v93, v101
    v_mfma_f32_16x16x32_bf16 v[64:67], v[220:223], a[20:23], v[64:67]
    v_add_u32 v8, 32768, v8
    buffer_load_dwordx4 v[220:223], v8, s[36:39], s8 offen offset:0 sc1
    s_mov_b32 s76, 13238272
    buffer_load_dwordx4 v[16:19], v1, s[36:39], s76 offen sc1
    buffer_load_dwordx4 v[20:23], v1, s[36:39], s76 offen offset:1024 sc1
    s_waitcnt vmcnt(22)
    v_mfma_f32_16x16x32_bf16 v[68:71], v[224:227], a[88:91], v[68:71]
    v_add_f32 v94, v94, v102
    v_mfma_f32_16x16x32_bf16 v[76:79], v[224:227], a[152:155], v[76:79]
    v_add_f32 v95, v95, v103
    v_mfma_f32_16x16x32_bf16 v[84:87], v[224:227], a[216:219], v[84:87]
    v_add_f32 v96, v96, v104
    v_mfma_f32_16x16x32_bf16 v[60:63], v[224:227], a[24:27], v[60:63]
    buffer_load_dwordx4 v[224:227], v8, s[36:39], s9 offen offset:0 sc1
    v_mfma_f32_16x16x32_bf16 v[72:75], v[228:231], a[88:91], v[72:75]
    v_add_f32 v97, v97, v105
    v_mfma_f32_16x16x32_bf16 v[80:83], v[228:231], a[152:155], v[80:83]
    v_add_f32 v98, v98, v106
    v_mfma_f32_16x16x32_bf16 v[88:91], v[228:231], a[216:219], v[88:91]
    v_add_f32 v99, v99, v107
    v_mfma_f32_16x16x32_bf16 v[64:67], v[228:231], a[24:27], v[64:67]
    buffer_load_dwordx4 v[228:231], v8, s[36:39], s10 offen offset:0 sc1
    s_waitcnt vmcnt(21)
    v_mfma_f32_16x16x32_bf16 v[68:71], v[232:235], a[92:95], v[68:71]
    v_mfma_f32_16x16x32_bf16 v[76:79], v[232:235], a[156:159], v[76:79]
    v_add_f32 v92, v92, v108
    v_mfma_f32_16x16x32_bf16 v[84:87], v[232:235], a[220:223], v[84:87]
    v_add_f32 v93, v93, v109
    v_mfma_f32_16x16x32_bf16 v[60:63], v[232:235], a[28:31], v[60:63]
    buffer_load_dwordx4 v[232:235], v8, s[36:39], s11 offen offset:0 sc1
    v_mfma_f32_16x16x32_bf16 v[72:75], v[236:239], a[92:95], v[72:75]
    v_add_f32 v94, v94, v110
    v_mfma_f32_16x16x32_bf16 v[80:83], v[236:239], a[156:159], v[80:83]
    v_add_f32 v95, v95, v111
    v_mfma_f32_16x16x32_bf16 v[88:91], v[236:239], a[220:223], v[88:91]
    v_add_f32 v96, v96, v112
    v_mfma_f32_16x16x32_bf16 v[64:67], v[236:239], a[28:31], v[64:67]
    buffer_load_dwordx4 v[236:239], v8, s[36:39], s12 offen offset:0 sc1
    s_waitcnt vmcnt(21)
    v_mfma_f32_16x16x32_bf16 v[68:71], v[240:243], a[96:99], v[68:71]
    v_add_f32 v97, v97, v113
    v_mfma_f32_16x16x32_bf16 v[76:79], v[240:243], a[160:163], v[76:79]
    v_add_f32 v98, v98, v114
    v_mfma_f32_16x16x32_bf16 v[84:87], v[240:243], a[224:227], v[84:87]
    v_add_f32 v99, v99, v115
    v_mfma_f32_16x16x32_bf16 v[60:63], v[240:243], a[32:35], v[60:63]
    buffer_load_dwordx4 v[240:243], v8, s[36:39], s13 offen offset:0 sc1
    v_mfma_f32_16x16x32_bf16 v[72:75], v[244:247], a[96:99], v[72:75]
    v_mfma_f32_16x16x32_bf16 v[80:83], v[244:247], a[160:163], v[80:83]
    v_add_f32 v92, v92, v116
    v_mfma_f32_16x16x32_bf16 v[88:91], v[244:247], a[224:227], v[88:91]
    v_add_f32 v93, v93, v117
    v_mfma_f32_16x16x32_bf16 v[64:67], v[244:247], a[32:35], v[64:67]
    buffer_load_dwordx4 v[244:247], v8, s[36:39], s14 offen offset:0 sc1
    s_waitcnt vmcnt(21)
    v_mfma_f32_16x16x32_bf16 v[68:71], v[248:251], a[100:103], v[68:71]
    v_add_f32 v94, v94, v118
    v_mfma_f32_16x16x32_bf16 v[76:79], v[248:251], a[164:167], v[76:79]
    v_add_f32 v95, v95, v119
    v_mfma_f32_16x16x32_bf16 v[84:87], v[248:251], a[228:231], v[84:87]
    v_add_f32 v96, v96, v120
    v_mfma_f32_16x16x32_bf16 v[60:63], v[248:251], a[36:39], v[60:63]
    buffer_load_dwordx4 v[248:251], v8, s[36:39], s15 offen offset:0 sc1
    v_mfma_f32_16x16x32_bf16 v[72:75], v[252:255], a[100:103], v[72:75]
    v_add_f32 v97, v97, v121
    v_mfma_f32_16x16x32_bf16 v[80:83], v[252:255], a[164:167], v[80:83]
    v_add_f32 v98, v98, v122
    v_mfma_f32_16x16x32_bf16 v[88:91], v[252:255], a[228:231], v[88:91]
    v_add_f32 v99, v99, v123
    v_mfma_f32_16x16x32_bf16 v[64:67], v[252:255], a[36:39], v[64:67]
    buffer_load_dwordx4 v[252:255], v8, s[36:39], s16 offen offset:0 sc1
    s_waitcnt vmcnt(21)
    v_mfma_f32_16x16x32_bf16 v[68:71], v[172:175], a[104:107], v[68:71]
    v_mul_f32 v92, v92, v40
    v_mfma_f32_16x16x32_bf16 v[76:79], v[172:175], a[168:171], v[76:79]
    v_mul_f32 v93, v93, v41
    v_mfma_f32_16x16x32_bf16 v[84:87], v[172:175], a[232:235], v[84:87]
    v_mul_f32 v94, v94, v42
    v_mfma_f32_16x16x32_bf16 v[60:63], v[172:175], a[40:43], v[60:63]
    buffer_load_dwordx4 v[172:175], v8, s[36:39], s17 offen offset:0 sc1
    v_mfma_f32_16x16x32_bf16 v[72:75], v[176:179], a[104:107], v[72:75]
    v_mul_f32 v95, v95, v43
    v_mfma_f32_16x16x32_bf16 v[80:83], v[176:179], a[168:171], v[80:83]
    v_mul_f32 v96, v96, v44
    v_mfma_f32_16x16x32_bf16 v[88:91], v[176:179], a[232:235], v[88:91]
    v_mul_f32 v97, v97, v45
    v_mfma_f32_16x16x32_bf16 v[64:67], v[176:179], a[40:43], v[64:67]
    buffer_load_dwordx4 v[176:179], v8, s[36:39], s18 offen offset:0 sc1
    s_waitcnt vmcnt(21)
    v_mfma_f32_16x16x32_bf16 v[68:71], v[180:183], a[108:111], v[68:71]
    v_mul_f32 v98, v98, v46
    v_mfma_f32_16x16x32_bf16 v[76:79], v[180:183], a[172:175], v[76:79]
    v_mul_f32 v99, v99, v47
    v_mfma_f32_16x16x32_bf16 v[84:87], v[180:183], a[236:239], v[84:87]
    v_cvt_pk_bf16_f32 v160, v92, v93
    v_mfma_f32_16x16x32_bf16 v[60:63], v[180:183], a[44:47], v[60:63]
    buffer_load_dwordx4 v[180:183], v8, s[36:39], s19 offen offset:0 sc1
    v_mfma_f32_16x16x32_bf16 v[72:75], v[184:187], a[108:111], v[72:75]
    v_cvt_pk_bf16_f32 v161, v94, v95
    v_mfma_f32_16x16x32_bf16 v[80:83], v[184:187], a[172:175], v[80:83]
    v_cvt_pk_bf16_f32 v162, v96, v97
    v_mfma_f32_16x16x32_bf16 v[88:91], v[184:187], a[236:239], v[88:91]
    v_cvt_pk_bf16_f32 v163, v98, v99
    v_mfma_f32_16x16x32_bf16 v[64:67], v[184:187], a[44:47], v[64:67]
    buffer_load_dwordx4 v[184:187], v8, s[36:39], s20 offen offset:0 sc1
    s_waitcnt vmcnt(21)
    v_mfma_f32_16x16x32_bf16 v[68:71], v[188:191], a[112:115], v[68:71]
    v_min_u32 v160, -2, v160
    v_mfma_f32_16x16x32_bf16 v[76:79], v[188:191], a[176:179], v[76:79]
    v_min_u32 v161, -2, v161
    v_mfma_f32_16x16x32_bf16 v[84:87], v[188:191], a[240:243], v[84:87]
    v_min_u32 v162, -2, v162
    v_mfma_f32_16x16x32_bf16 v[60:63], v[188:191], a[48:51], v[60:63]
    buffer_load_dwordx4 v[188:191], v8, s[36:39], s21 offen offset:0 sc1
    v_mfma_f32_16x16x32_bf16 v[72:75], v[192:195], a[112:115], v[72:75]
    v_min_u32 v163, -2, v163
    v_mfma_f32_16x16x32_bf16 v[80:83], v[192:195], a[176:179], v[80:83]
    s_add_u32 s76, s85, 8192
    buffer_store_dwordx4 v[160:163], v1, s[36:39], s76 offen sc1
    v_mfma_f32_16x16x32_bf16 v[88:91], v[192:195], a[240:243], v[88:91]
    v_sin_f32 v169, v169
    v_mfma_f32_16x16x32_bf16 v[64:67], v[192:195], a[48:51], v[64:67]
    buffer_load_dwordx4 v[192:195], v8, s[36:39], s22 offen offset:0 sc1
    s_waitcnt vmcnt(15)
    s_mov_b32 s82, 0
L_fwca0000:
    v_xor_b32 v16, s56, v16
    v_xor_b32 v17, s57, v17
    v_xor_b32 v18, s56, v18
    v_xor_b32 v19, s57, v19
    v_xor_b32 v20, s56, v20
    v_xor_b32 v21, s57, v21
    v_xor_b32 v22, s56, v22
    v_xor_b32 v23, s57, v23
    v_or3_b32 v16, v16, v17, v18
    v_or3_b32 v19, v19, v20, v21
    v_or3_b32 v16, v16, v22, v23
    v_or_b32 v16, v16, v19
    v_cmp_ne_u32 vcc, 0, v16
    s_cbranch_vccz L_fwca0000_ok
    s_add_u32 s82, s82, 1
    s_cmp_ge_u32 s82, 200000
    s_cbranch_scc1 L_fwca0000_ok
    s_mov_b32 s76, 13238272
    buffer_load_dwordx4 v[16:19], v1, s[36:39], s76 offen sc1
    buffer_load_dwordx4 v[20:23], v1, s[36:39], s76 offen offset:1024 sc1
    s_waitcnt vmcnt(0)
    s_branch L_fwca0000
L_fwca0000_ok:
    s_waitcnt vmcnt(22)
    v_mfma_f32_16x16x32_bf16 v[68:71], v[196:199], a[116:119], v[68:71]
    v_cos_f32 v146, v170
    v_mfma_f32_16x16x32_bf16 v[76:79], v[196:199], a[180:183], v[76:79]
    v_sin_f32 v170, v170
    v_mfma_f32_16x16x32_bf16 v[84:87], v[196:199], a[244:247], v[84:87]
    v_cos_f32 v147, v171
    v_mfma_f32_16x16x32_bf16 v[60:63], v[196:199], a[52:55], v[60:63]
    buffer_load_dwordx4 v[196:199], v8, s[36:39], s23 offen offset:0 sc1
    v_mfma_f32_16x16x32_bf16 v[72:75], v[200:203], a[116:119], v[72:75]
    v_sin_f32 v171, v171
    v_mfma_f32_16x16x32_bf16 v[80:83], v[200:203], a[180:183], v[80:83]
    v_cvt_pk_bf16_f32 v144, v144, v168
    v_mfma_f32_16x16x32_bf16 v[88:91], v[200:203], a[244:247], v[88:91]
    v_cvt_pk_bf16_f32 v145, v145, v169
    v_mfma_f32_16x16x32_bf16 v[64:67], v[200:203], a[52:55], v[64:67]
    s_waitcnt vmcnt(21)
    v_mfma_f32_16x16x32_bf16 v[68:71], v[204:207], a[120:123], v[68:71]
    v_cvt_pk_bf16_f32 v146, v146, v170
    v_mfma_f32_16x16x32_bf16 v[76:79], v[204:207], a[184:187], v[76:79]
    v_cvt_pk_bf16_f32 v147, v147, v171
    v_mfma_f32_16x16x32_bf16 v[84:87], v[204:207], a[248:251], v[84:87]
    v_fmamk_f32 v168, v165, 0x42000000, v166
    v_mfma_f32_16x16x32_bf16 v[60:63], v[204:207], a[56:59], v[60:63]
    s_mul_i32 s89, s94, 0
    s_add_u32 s89, s89, s80
    buffer_load_dwordx4 v[200:203], v5, s[36:39], s89 offen offset:0 sc1
    buffer_load_dwordx4 v[204:207], v5, s[36:39], s89 offen offset:1024 sc1
    v_mfma_f32_16x16x32_bf16 v[72:75], v[208:211], a[120:123], v[72:75]
    v_fmamk_f32 v169, v165, 0x42040000, v166
    v_mfma_f32_16x16x32_bf16 v[80:83], v[208:211], a[184:187], v[80:83]
    v_fmamk_f32 v170, v165, 0x42080000, v166
    v_mfma_f32_16x16x32_bf16 v[88:91], v[208:211], a[248:251], v[88:91]
    v_fmamk_f32 v171, v165, 0x420c0000, v166
    v_mfma_f32_16x16x32_bf16 v[64:67], v[208:211], a[56:59], v[64:67]
    s_waitcnt vmcnt(21)
    v_mfma_f32_16x16x32_bf16 v[68:71], v[212:215], a[124:127], v[68:71]
    v_cos_f32 v148, v168
    v_mfma_f32_16x16x32_bf16 v[76:79], v[212:215], a[188:191], v[76:79]
    v_sin_f32 v168, v168
    v_mfma_f32_16x16x32_bf16 v[84:87], v[212:215], a[252:255], v[84:87]
    v_cos_f32 v149, v169
    v_mfma_f32_16x16x32_bf16 v[60:63], v[212:215], a[60:63], v[60:63]
    s_mul_i32 s89, s94, 1
    s_add_u32 s89, s89, s80
    buffer_load_dwordx4 v[208:211], v5, s[36:39], s89 offen offset:0 sc1
    buffer_load_dwordx4 v[212:215], v5, s[36:39], s89 offen offset:1024 sc1
    v_mfma_f32_16x16x32_bf16 v[72:75], v[216:219], a[124:127], v[72:75]
    v_sin_f32 v169, v169
    v_mfma_f32_16x16x32_bf16 v[80:83], v[216:219], a[188:191], v[80:83]
    v_cos_f32 v150, v170
    v_mfma_f32_16x16x32_bf16 v[88:91], v[216:219], a[252:255], v[88:91]
    v_sin_f32 v170, v170
    v_mfma_f32_16x16x32_bf16 v[64:67], v[216:219], a[60:63], v[64:67]
    s_waitcnt vmcnt(19)
    v_mfma_f32_16x16x32_bf16 v[100:103], v[220:223], a[64:67], 0
    ds_write_b128 v10, v[68:71] offset:32768
    v_mfma_f32_16x16x32_bf16 v[108:111], v[220:223], a[128:131], 0
    v_cos_f32 v151, v171
    ds_write_b128 v10, v[72:75] offset:33792
    v_mfma_f32_16x16x32_bf16 v[116:119], v[220:223], a[192:195], 0
    v_sin_f32 v171, v171
    v_mfma_f32_16x16x32_bf16 v[92:95], v[220:223], a[0:3], v[156:159]
    s_mul_i32 s89, s94, 2
    s_add_u32 s89, s89, s80
    buffer_load_dwordx4 v[216:219], v5, s[36:39], s89 offen offset:0 sc1
    buffer_load_dwordx4 v[220:223], v5, s[36:39], s89 offen offset:1024 sc1
    v_mfma_f32_16x16x32_bf16 v[100:103], v[224:227], a[68:71], v[100:103]
    ds_write_b128 v28, v[76:79] offset:34816
    v_mfma_f32_16x16x32_bf16 v[108:111], v[224:227], a[132:135], v[108:111]
    v_cvt_pk_bf16_f32 v148, v148, v168
    ds_write_b128 v28, v[80:83] offset:35840
    v_mfma_f32_16x16x32_bf16 v[116:119], v[224:227], a[196:199], v[116:119]
    v_cvt_pk_bf16_f32 v149, v149, v169
    v_mfma_f32_16x16x32_bf16 v[92:95], v[224:227], a[4:7], v[92:95]
    s_waitcnt vmcnt(19)
    v_mfma_f32_16x16x32_bf16 v[100:103], v[228:231], a[72:75], v[100:103]
    ds_write_b128 v29, v[84:87] offset:36864
    v_mfma_f32_16x16x32_bf16 v[108:111], v[228:231], a[136:139], v[108:111]
    v_cvt_pk_bf16_f32 v150, v150, v170
    ds_write_b128 v29, v[88:91] offset:37888
    v_mfma_f32_16x16x32_bf16 v[116:119], v[228:231], a[200:203], v[116:119]
    v_cvt_pk_bf16_f32 v151, v151, v171
    v_mfma_f32_16x16x32_bf16 v[92:95], v[228:231], a[8:11], v[92:95]
    s_mul_i32 s89, s94, 3
    s_add_u32 s89, s89, s80
    buffer_load_dwordx4 v[224:227], v5, s[36:39], s89 offen offset:0 sc1
    buffer_load_dwordx4 v[228:231], v5, s[36:39], s89 offen offset:1024 sc1
    v_mfma_f32_16x16x32_bf16 v[100:103], v[232:235], a[76:79], v[100:103]
    v_fmamk_f32 v168, v165, 0x42400000, v166
    v_mfma_f32_16x16x32_bf16 v[108:111], v[232:235], a[140:143], v[108:111]
    v_fmamk_f32 v169, v165, 0x42440000, v166
    s_waitcnt vmcnt(63) lgkmcnt(0)
    s_barrier
    v_mfma_f32_16x16x32_bf16 v[116:119], v[232:235], a[204:207], v[116:119]
    ds_read_b128 v[68:71], v2 offset:32768
    ds_read_b128 v[72:75], v2 offset:33792
    v_mfma_f32_16x16x32_bf16 v[92:95], v[232:235], a[12:15], v[92:95]
    s_waitcnt vmcnt(19)
    v_mfma_f32_16x16x32_bf16 v[100:103], v[236:239], a[80:83], v[100:103]
    ds_read_b128 v[76:79], v2 offset:34816
    ds_read_b128 v[80:83], v2 offset:35840
    v_mfma_f32_16x16x32_bf16 v[108:111], v[236:239], a[144:147], v[108:111]
    ds_read_b128 v[84:87], v2 offset:36864
    ds_read_b128 v[88:91], v2 offset:37888
    v_mfma_f32_16x16x32_bf16 v[116:119], v[236:239], a[208:211], v[116:119]
    v_fmamk_f32 v170, v165, 0x42480000, v166
    v_mfma_f32_16x16x32_bf16 v[92:95], v[236:239], a[16:19], v[92:95]
    s_mul_i32 s89, s94, 0
    s_add_u32 s89, s89, s80
    buffer_load_dwordx4 a[0:3], v5, s[36:39], s89 offen offset:2048 sc1
    buffer_load_dwordx4 a[4:7], v5, s[36:39], s89 offen offset:3072 sc1
    v_mfma_f32_16x16x32_bf16 v[100:103], v[240:243], a[84:87], v[100:103]
    v_fmamk_f32 v171, v165, 0x424c0000, v166
    v_mfma_f32_16x16x32_bf16 v[108:111], v[240:243], a[148:151], v[108:111]
    s_waitcnt lgkmcnt(0)
    s_barrier
    v_mfma_f32_16x16x32_bf16 v[116:119], v[240:243], a[212:215], v[116:119]
    v_add_f32 v60, v60, v68
    v_add_f32 v61, v61, v69
    v_mfma_f32_16x16x32_bf16 v[92:95], v[240:243], a[20:23], v[92:95]
    s_waitcnt vmcnt(19)
    v_mfma_f32_16x16x32_bf16 v[100:103], v[244:247], a[88:91], v[100:103]
    v_add_f32 v62, v62, v70
    v_add_f32 v63, v63, v71
    v_mfma_f32_16x16x32_bf16 v[108:111], v[244:247], a[152:155], v[108:111]
    v_add_f32 v64, v64, v72
    v_add_f32 v65, v65, v73
    v_mfma_f32_16x16x32_bf16 v[116:119], v[244:247], a[216:219], v[116:119]
    v_add_f32 v66, v66, v74
    v_add_f32 v67, v67, v75
    v_mfma_f32_16x16x32_bf16 v[92:95], v[244:247], a[24:27], v[92:95]
    s_mul_i32 s89, s94, 1
    s_add_u32 s89, s89, s80
    buffer_load_dwordx4 a[64:67], v5, s[36:39], s89 offen offset:2048 sc1
    buffer_load_dwordx4 a[68:71], v5, s[36:39], s89 offen offset:3072 sc1
    v_mfma_f32_16x16x32_bf16 v[100:103], v[248:251], a[92:95], v[100:103]
    v_add_f32 v60, v60, v76
    v_mfma_f32_16x16x32_bf16 v[108:111], v[248:251], a[156:159], v[108:111]
    v_add_f32 v61, v61, v77
    v_add_f32 v62, v62, v78
    v_mfma_f32_16x16x32_bf16 v[116:119], v[248:251], a[220:223], v[116:119]
    v_add_f32 v63, v63, v79
    v_add_f32 v64, v64, v80
    v_mfma_f32_16x16x32_bf16 v[92:95], v[248:251], a[28:31], v[92:95]
    s_waitcnt vmcnt(19)
    v_mfma_f32_16x16x32_bf16 v[100:103], v[252:255], a[96:99], v[100:103]
    v_add_f32 v65, v65, v81
    v_add_f32 v66, v66, v82
    v_mfma_f32_16x16x32_bf16 v[108:111], v[252:255], a[160:163], v[108:111]
    v_add_f32 v67, v67, v83
    v_mfma_f32_16x16x32_bf16 v[116:119], v[252:255], a[224:227], v[116:119]
    v_add_f32 v60, v60, v84
    v_add_f32 v61, v61, v85
    v_mfma_f32_16x16x32_bf16 v[92:95], v[252:255], a[32:35], v[92:95]
    s_mul_i32 s89, s94, 2
    s_add_u32 s89, s89, s80
    buffer_load_dwordx4 a[128:131], v5, s[36:39], s89 offen offset:2048 sc1
    buffer_load_dwordx4 a[132:135], v5, s[36:39], s89 offen offset:3072 sc1
    v_mfma_f32_16x16x32_bf16 v[100:103], v[172:175], a[100:103], v[100:103]
    v_add_f32 v62, v62, v86
    v_add_f32 v63, v63, v87
    v_mfma_f32_16x16x32_bf16 v[108:111], v[172:175], a[164:167], v[108:111]
    v_add_f32 v64, v64, v88
    v_add_f32 v65, v65, v89
    v_mfma_f32_16x16x32_bf16 v[116:119], v[172:175], a[228:231], v[116:119]
    v_add_f32 v66, v66, v90
    v_add_f32 v67, v67, v91
    v_mfma_f32_16x16x32_bf16 v[92:95], v[172:175], a[36:39], v[92:95]
    s_waitcnt vmcnt(19)
    v_mfma_f32_16x16x32_bf16 v[100:103], v[176:179], a[104:107], v[100:103]
    v_mul_f32 v60, v60, v48
    v_mul_f32 v61, v61, v49
    v_mfma_f32_16x16x32_bf16 v[108:111], v[176:179], a[168:171], v[108:111]
    v_mul_f32 v62, v62, v50
    v_mul_f32 v63, v63, v51
    v_mfma_f32_16x16x32_bf16 v[116:119], v[176:179], a[232:235], v[116:119]
    v_mul_f32 v64, v64, v52
    v_mul_f32 v65, v65, v53
    v_mfma_f32_16x16x32_bf16 v[92:95], v[176:179], a[40:43], v[92:95]
    s_mul_i32 s89, s94, 3
    s_add_u32 s89, s89, s80
    buffer_load_dwordx4 a[192:195], v5, s[36:39], s89 offen offset:2048 sc1
    buffer_load_dwordx4 a[196:199], v5, s[36:39], s89 offen offset:3072 sc1
    v_mfma_f32_16x16x32_bf16 v[100:103], v[180:183], a[108:111], v[100:103]
    v_mul_f32 v66, v66, v54
    v_mul_f32 v67, v67, v55
    v_mfma_f32_16x16x32_bf16 v[108:111], v[180:183], a[172:175], v[108:111]
    v_cvt_pk_bf16_f32 v160, v60, v61
    v_cvt_pk_bf16_f32 v161, v62, v63
    v_mfma_f32_16x16x32_bf16 v[116:119], v[180:183], a[236:239], v[116:119]
    v_cvt_pk_bf16_f32 v162, v64, v65
    v_cvt_pk_bf16_f32 v163, v66, v67
    v_mfma_f32_16x16x32_bf16 v[92:95], v[180:183], a[44:47], v[92:95]
    s_lshl_b32 s89, s90, 6
    s_add_u32 s89, s89, 13107200
    buffer_load_dword v156, v25, s[36:39], s89 offen sc1
    s_lshl_b32 s89, s91, 6
    s_add_u32 s89, s89, 13107200
    buffer_load_dword v158, v25, s[36:39], s89 offen sc1
    s_waitcnt vmcnt(21)
    v_mfma_f32_16x16x32_bf16 v[100:103], v[184:187], a[112:115], v[100:103]
    v_min_u32 v160, -2, v160
    v_min_u32 v161, -2, v161
    v_mfma_f32_16x16x32_bf16 v[108:111], v[184:187], a[176:179], v[108:111]
    v_min_u32 v162, -2, v162
    v_min_u32 v163, -2, v163
    v_mfma_f32_16x16x32_bf16 v[116:119], v[184:187], a[240:243], v[116:119]
    s_add_u32 s76, s85, 16384
    buffer_store_dwordx4 v[160:163], v1, s[36:39], s76 offen sc1
    v_add_u32 v7, 116592, v7
    v_add_u32 v11, 116592, v11
    v_add_u32 v12, 116592, v12
    v_add_u32 v24, 116592, v24
    ds_read_b64_tr_b16 a[8:9], v7 offset:0
    ds_read_b64_tr_b16 a[10:11], v7 offset:2048
    v_mfma_f32_16x16x32_bf16 v[92:95], v[184:187], a[48:51], v[92:95]
    s_add_u32 s88, s93, 0
    buffer_load_dwordx4 v[232:235], v1, s[36:39], s88 offen offset:0 sc1
    v_mfma_f32_16x16x32_bf16 v[100:103], v[188:191], a[116:119], v[100:103]
    v_cos_f32 v152, v168
    ds_read_b64_tr_b16 a[72:73], v11 offset:0
    ds_read_b64_tr_b16 a[74:75], v11 offset:2048
    v_mfma_f32_16x16x32_bf16 v[108:111], v[188:191], a[180:183], v[108:111]
    v_sin_f32 v168, v168
    ds_read_b64_tr_b16 a[136:137], v12 offset:0
    ds_read_b64_tr_b16 a[138:139], v12 offset:2048
    v_mfma_f32_16x16x32_bf16 v[116:119], v[188:191], a[244:247], v[116:119]
    v_cos_f32 v153, v169
    ds_read_b64_tr_b16 a[200:201], v24 offset:0
    ds_read_b64_tr_b16 a[202:203], v24 offset:2048
    v_mfma_f32_16x16x32_bf16 v[92:95], v[188:191], a[52:55], v[92:95]
    buffer_load_dwordx4 v[236:239], v1, s[36:39], s88 offen offset:1024 sc1
    s_waitcnt vmcnt(21)
    v_mfma_f32_16x16x32_bf16 v[100:103], v[192:195], a[120:123], v[100:103]
    v_sin_f32 v169, v169
    ds_read_b64_tr_b16 a[12:13], v7 offset:4096
    ds_read_b64_tr_b16 a[14:15], v7 offset:6144
    v_mfma_f32_16x16x32_bf16 v[108:111], v[192:195], a[184:187], v[108:111]
    v_cos_f32 v154, v170
    ds_read_b64_tr_b16 a[76:77], v11 offset:4096
    ds_read_b64_tr_b16 a[78:79], v11 offset:6144
    v_mfma_f32_16x16x32_bf16 v[116:119], v[192:195], a[248:251], v[116:119]
    v_sin_f32 v170, v170
    ds_read_b64_tr_b16 a[140:141], v12 offset:4096
    ds_read_b64_tr_b16 a[142:143], v12 offset:6144
    v_mfma_f32_16x16x32_bf16 v[92:95], v[192:195], a[56:59], v[92:95]
    buffer_load_dwordx4 v[240:243], v1, s[36:39], s88 offen offset:2048 sc1
    v_mfma_f32_16x16x32_bf16 v[100:103], v[196:199], a[124:127], v[100:103]
    v_cos_f32 v155, v171
    ds_read_b64_tr_b16 a[204:205], v24 offset:4096
    ds_read_b64_tr_b16 a[206:207], v24 offset:6144
    v_mfma_f32_16x16x32_bf16 v[108:111], v[196:199], a[188:191], v[108:111]
    v_sin_f32 v171, v171
    ds_read_b64_tr_b16 a[16:17], v7 offset:16656
    ds_read_b64_tr_b16 a[18:19], v7 offset:18704
    v_mfma_f32_16x16x32_bf16 v[116:119], v[196:199], a[252:255], v[116:119]
    v_cvt_pk_bf16_f32 v152, v152, v168
    ds_read_b64_tr_b16 a[80:81], v11 offset:16656
    ds_read_b64_tr_b16 a[82:83], v11 offset:18704
    v_mfma_f32_16x16x32_bf16 v[92:95], v[196:199], a[60:63], v[92:95]
    buffer_load_dwordx4 v[244:247], v1, s[36:39], s88 offen offset:3072 sc1
    v_cvt_pk_bf16_f32 v153, v153, v169
    v_cvt_pk_bf16_f32 v154, v154, v170
    v_cvt_pk_bf16_f32 v155, v155, v171
    ds_write_b128 v10, v[100:103] offset:32768
    ds_write_b128 v28, v[108:111] offset:34816
    ds_write_b128 v29, v[116:119] offset:36864
    s_waitcnt vmcnt(63) lgkmcnt(0)
    s_barrier
    ds_read_b128 v[100:103], v2 offset:32768
    ds_read_b128 v[108:111], v2 offset:34816
    ds_read_b128 v[116:119], v2 offset:36864
    s_waitcnt lgkmcnt(2)
    v_pk_add_f32 v[92:93], v[92:93], v[100:101]
    v_pk_add_f32 v[94:95], v[94:95], v[102:103]
    s_waitcnt lgkmcnt(1)
    v_pk_add_f32 v[92:93], v[92:93], v[108:109]
    v_pk_add_f32 v[94:95], v[94:95], v[110:111]
    s_waitcnt lgkmcnt(0)
    v_pk_add_f32 v[92:93], v[92:93], v[116:117]
    v_pk_add_f32 v[94:95], v[94:95], v[118:119]
    v_mul_f32 v92, v92, v56
    v_mul_f32 v93, v93, v57
    v_mul_f32 v94, v94, v58
    v_mul_f32 v95, v95, v59
    v_cvt_pk_bf16_f32 v160, v92, v93
    v_cvt_pk_bf16_f32 v161, v94, v95
    v_min_u32 v160, -2, v160
    v_min_u32 v161, -2, v161
    v_mov_b32 v162, v160
    v_mov_b32 v163, v161
    s_nop 0
    v_permlane32_swap_b32 v160, v162
    v_permlane32_swap_b32 v161, v163
    s_mov_b64 exec, s[66:67]
    buffer_store_dwordx4 v[160:163], v1, s[36:39], s86 offen sc1
    s_mov_b64 exec, -1
    s_barrier
    s_xor_b32 s76, s54, 1
    s_lshl_b32 s76, s76, 12
    v_add_u32 v14, s76, v1
    v_add_u32 v16, s6, v1
    s_lshl_b32 s81, s90, 10
    s_lshl_b32 s77, s53, 7
    s_add_u32 s81, s81, s77
    s_mov_b32 s82, 0
    s_waitcnt vmcnt(6)
    v_mfma_f32_16x16x32_bf16 v[92:95], v[200:203], v[124:127], 0
    ds_read_b64_tr_b16 a[144:145], v12 offset:16656
    ds_read_b64_tr_b16 a[146:147], v12 offset:18704
    v_mfma_f32_16x16x32_bf16 v[96:99], v[208:211], v[124:127], 0
    ds_read_b64_tr_b16 a[208:209], v24 offset:16656
    ds_read_b64_tr_b16 a[210:211], v24 offset:18704
    v_mfma_f32_16x16x32_bf16 v[100:103], v[216:219], v[124:127], 0
    ds_read_b64_tr_b16 a[20:21], v7 offset:20752
    ds_read_b64_tr_b16 a[22:23], v7 offset:22800
    s_add_u32 s88, s92, 0
    buffer_load_dwordx4 v[248:251], v1, s[36:39], s88 offen offset:0 sc1
    v_mfma_f32_16x16x32_bf16 v[104:107], v[224:227], v[124:127], 0
    ds_read_b64_tr_b16 a[84:85], v11 offset:20752
    ds_read_b64_tr_b16 a[86:87], v11 offset:22800
    v_mfma_f32_16x16x32_bf16 v[108:111], v[200:203], v[140:143], 0
    ds_read_b64_tr_b16 a[148:149], v12 offset:20752
    ds_read_b64_tr_b16 a[150:151], v12 offset:22800
    v_mfma_f32_16x16x32_bf16 v[112:115], v[208:211], v[140:143], 0
    ds_read_b64_tr_b16 a[212:213], v24 offset:20752
    ds_read_b64_tr_b16 a[214:215], v24 offset:22800
    buffer_load_dwordx4 v[252:255], v1, s[36:39], s88 offen offset:1024 sc1
    v_mfma_f32_16x16x32_bf16 v[116:119], v[216:219], v[140:143], 0
    v_subrev_u32 v7, 49968, v7
    v_subrev_u32 v11, 49968, v11
    v_subrev_u32 v12, 49968, v12
    v_subrev_u32 v24, 49968, v24
    ds_read_b64_tr_b16 a[24:25], v7 offset:0
    ds_read_b64_tr_b16 a[26:27], v7 offset:2048
    v_mfma_f32_16x16x32_bf16 v[120:123], v[224:227], v[140:143], 0
    ds_read_b64_tr_b16 a[88:89], v11 offset:0
    ds_read_b64_tr_b16 a[90:91], v11 offset:2048
    v_mfma_f32_16x16x32_bf16 v[92:95], v[204:207], v[128:131], v[92:95]
    ds_read_b64_tr_b16 a[152:153], v12 offset:0
    ds_read_b64_tr_b16 a[154:155], v12 offset:2048
    buffer_load_dwordx4 v[172:175], v1, s[36:39], s88 offen offset:2048 sc1
    v_mfma_f32_16x16x32_bf16 v[96:99], v[212:215], v[128:131], v[96:99]
    ds_read_b64_tr_b16 a[216:217], v24 offset:0
    ds_read_b64_tr_b16 a[218:219], v24 offset:2048
    v_mfma_f32_16x16x32_bf16 v[100:103], v[220:223], v[128:131], v[100:103]
    ds_read_b64_tr_b16 a[28:29], v7 offset:4096
    ds_read_b64_tr_b16 a[30:31], v7 offset:6144
    v_mfma_f32_16x16x32_bf16 v[104:107], v[228:231], v[128:131], v[104:107]
    ds_read_b64_tr_b16 a[92:93], v11 offset:4096
    ds_read_b64_tr_b16 a[94:95], v11 offset:6144
    buffer_load_dwordx4 v[176:179], v1, s[36:39], s88 offen offset:3072 sc1
    v_mfma_f32_16x16x32_bf16 v[108:111], v[204:207], v[144:147], v[108:111]
    ds_read_b64_tr_b16 a[156:157], v12 offset:4096
    ds_read_b64_tr_b16 a[158:159], v12 offset:6144
    v_mfma_f32_16x16x32_bf16 v[112:115], v[212:215], v[144:147], v[112:115]
    ds_read_b64_tr_b16 a[220:221], v24 offset:4096
    ds_read_b64_tr_b16 a[222:223], v24 offset:6144
    v_mfma_f32_16x16x32_bf16 v[116:119], v[220:223], v[144:147], v[116:119]
    ds_read_b64_tr_b16 a[32:33], v7 offset:16656
    ds_read_b64_tr_b16 a[34:35], v7 offset:18704
    s_add_u32 s88, s93, 8192
    buffer_load_dwordx4 v[180:183], v1, s[36:39], s88 offen offset:0 sc1
    v_mfma_f32_16x16x32_bf16 v[120:123], v[228:231], v[144:147], v[120:123]
    ds_read_b64_tr_b16 a[96:97], v11 offset:16656
    ds_read_b64_tr_b16 a[98:99], v11 offset:18704
    v_mfma_f32_16x16x32_bf16 v[92:95], a[0:3], v[132:135], v[92:95]
    ds_read_b64_tr_b16 a[160:161], v12 offset:16656
    ds_read_b64_tr_b16 a[162:163], v12 offset:18704
    v_mfma_f32_16x16x32_bf16 v[96:99], a[64:67], v[132:135], v[96:99]
    ds_read_b64_tr_b16 a[224:225], v24 offset:16656
    ds_read_b64_tr_b16 a[226:227], v24 offset:18704
    buffer_load_dwordx4 v[184:187], v1, s[36:39], s88 offen offset:1024 sc1
    v_mfma_f32_16x16x32_bf16 v[100:103], a[128:131], v[132:135], v[100:103]
    ds_read_b64_tr_b16 a[36:37], v7 offset:20752
    ds_read_b64_tr_b16 a[38:39], v7 offset:22800
    v_mfma_f32_16x16x32_bf16 v[104:107], a[192:195], v[132:135], v[104:107]
    ds_read_b64_tr_b16 a[100:101], v11 offset:20752
    ds_read_b64_tr_b16 a[102:103], v11 offset:22800
    v_mfma_f32_16x16x32_bf16 v[108:111], a[0:3], v[148:151], v[108:111]
    ds_read_b64_tr_b16 a[164:165], v12 offset:20752
    ds_read_b64_tr_b16 a[166:167], v12 offset:22800
    buffer_load_dwordx4 v[188:191], v1, s[36:39], s88 offen offset:2048 sc1
    v_mfma_f32_16x16x32_bf16 v[112:115], a[64:67], v[148:151], v[112:115]
    ds_read_b64_tr_b16 a[228:229], v24 offset:20752
    ds_read_b64_tr_b16 a[230:231], v24 offset:22800
    v_mfma_f32_16x16x32_bf16 v[116:119], a[128:131], v[148:151], v[116:119]
    ds_read_b64_tr_b16 a[40:41], v7 offset:33312
    ds_read_b64_tr_b16 a[42:43], v7 offset:35360
    v_mfma_f32_16x16x32_bf16 v[120:123], a[192:195], v[148:151], v[120:123]
    ds_read_b64_tr_b16 a[104:105], v11 offset:33312
    ds_read_b64_tr_b16 a[106:107], v11 offset:35360
    buffer_load_dwordx4 v[192:195], v1, s[36:39], s88 offen offset:3072 sc1
    v_mfma_f32_16x16x32_bf16 v[92:95], a[4:7], v[136:139], v[92:95]
    ds_read_b64_tr_b16 a[168:169], v12 offset:33312
    ds_read_b64_tr_b16 a[170:171], v12 offset:35360
    v_mfma_f32_16x16x32_bf16 v[96:99], a[68:71], v[136:139], v[96:99]
    ds_read_b64_tr_b16 a[232:233], v24 offset:33312
    ds_read_b64_tr_b16 a[234:235], v24 offset:35360
    v_mfma_f32_16x16x32_bf16 v[100:103], a[132:135], v[136:139], v[100:103]
    ds_read_b64_tr_b16 a[44:45], v7 offset:37408
    ds_read_b64_tr_b16 a[46:47], v7 offset:39456
    s_add_u32 s88, s92, 8192
    buffer_load_dwordx4 v[196:199], v1, s[36:39], s88 offen offset:0 sc1
    v_mfma_f32_16x16x32_bf16 v[104:107], a[196:199], v[136:139], v[104:107]
    ds_read_b64_tr_b16 a[108:109], v11 offset:37408
    ds_read_b64_tr_b16 a[110:111], v11 offset:39456
    v_mfma_f32_16x16x32_bf16 v[108:111], a[4:7], v[152:155], v[108:111]
    ds_read_b64_tr_b16 a[172:173], v12 offset:37408
    ds_read_b64_tr_b16 a[174:175], v12 offset:39456
    v_mfma_f32_16x16x32_bf16 v[112:115], a[68:71], v[152:155], v[112:115]
    ds_read_b64_tr_b16 a[236:237], v24 offset:37408
    ds_read_b64_tr_b16 a[238:239], v24 offset:39456
    buffer_load_dwordx4 v[60:63], v1, s[36:39], s88 offen offset:1024 sc1
    v_mfma_f32_16x16x32_bf16 v[116:119], a[132:135], v[152:155], v[116:119]
    v_subrev_u32 v7, 66624, v7
    v_subrev_u32 v11, 66624, v11
    v_subrev_u32 v12, 66624, v12
    v_subrev_u32 v24, 66624, v24
    ds_read_b64_tr_b16 a[48:49], v7 offset:0
    ds_read_b64_tr_b16 a[50:51], v7 offset:2048
    v_mfma_f32_16x16x32_bf16 v[120:123], a[196:199], v[152:155], v[120:123]
    ds_read_b64_tr_b16 a[112:113], v11 offset:0
    ds_read_b64_tr_b16 a[114:115], v11 offset:2048
    s_waitcnt vmcnt(6)
    v_max3_u32 v23, v232, v233, v234
    ds_read_b64_tr_b16 a[176:177], v12 offset:0
    v_max3_u32 v23, v23, v235, v236
    ds_read_b64_tr_b16 a[178:179], v12 offset:2048
    v_max3_u32 v23, v23, v237, v238
    ds_read_b64_tr_b16 a[240:241], v24 offset:0
    buffer_load_dwordx4 v[64:67], v1, s[36:39], s88 offen offset:2048 sc1
    v_max3_u32 v23, v23, v239, v240
    ds_read_b64_tr_b16 a[242:243], v24 offset:2048
    v_max3_u32 v23, v23, v241, v242
    ds_read_b64_tr_b16 a[52:53], v7 offset:4096
    v_max3_u32 v23, v23, v243, v244
    ds_read_b64_tr_b16 a[54:55], v7 offset:6144
    buffer_load_dwordx4 v[68:71], v1, s[36:39], s88 offen offset:3072 sc1
    v_max3_u32 v23, v23, v245, v246
    ds_read_b64_tr_b16 a[116:117], v11 offset:4096
    v_max3_u32 v23, v23, v247, v248
    ds_read_b64_tr_b16 a[118:119], v11 offset:6144
    v_max3_u32 v23, v23, v249, v250
    ds_read_b64_tr_b16 a[180:181], v12 offset:4096
    s_add_u32 s88, s93, 16384
    buffer_load_dwordx4 v[72:75], v1, s[36:39], s88 offen offset:0 sc1
    v_max3_u32 v23, v23, v251, v252
    ds_read_b64_tr_b16 a[182:183], v12 offset:6144
    v_max3_u32 v23, v23, v253, v254
    ds_read_b64_tr_b16 a[244:245], v24 offset:4096
    v_max3_u32 v23, v23, v255, v172
    ds_read_b64_tr_b16 a[246:247], v24 offset:6144
    buffer_load_dwordx4 v[76:79], v1, s[36:39], s88 offen offset:1024 sc1
    v_max3_u32 v23, v23, v173, v174
    ds_read_b64_tr_b16 a[56:57], v7 offset:16384
    v_max3_u32 v23, v23, v175, v176
    ds_read_b64_tr_b16 a[58:59], v7 offset:18432
    v_max3_u32 v23, v23, v177, v178
    ds_read_b64_tr_b16 a[120:121], v11 offset:16384
    buffer_load_dwordx4 v[80:83], v1, s[36:39], s88 offen offset:2048 sc1
    v_max_u32 v23, v23, v179
    ds_read_b64_tr_b16 a[122:123], v11 offset:18432
    v_cmp_eq_u32 vcc, -1, v23
    ds_read_b64_tr_b16 a[184:185], v12 offset:16384
    v_pk_mul_f32 v[92:93], v[92:93], v[156:157] op_sel_hi:[1,0]
    ds_read_b64_tr_b16 a[186:187], v12 offset:18432
    buffer_load_dwordx4 v[84:87], v1, s[36:39], s88 offen offset:3072 sc1
    v_pk_mul_f32 v[94:95], v[94:95], v[156:157] op_sel_hi:[1,0]
    ds_read_b64_tr_b16 a[248:249], v24 offset:16384
    v_pk_mul_f32 v[96:97], v[96:97], v[156:157] op_sel_hi:[1,0]
    ds_read_b64_tr_b16 a[250:251], v24 offset:18432
    v_pk_mul_f32 v[98:99], v[98:99], v[156:157] op_sel_hi:[1,0]
    ds_read_b64_tr_b16 a[60:61], v7 offset:20480
    s_add_u32 s88, s92, 16384
    buffer_load_dwordx4 v[88:91], v1, s[36:39], s88 offen offset:0 sc1
    v_pk_mul_f32 v[100:101], v[100:101], v[156:157] op_sel_hi:[1,0]
    ds_read_b64_tr_b16 a[62:63], v7 offset:22528
    v_pk_mul_f32 v[102:103], v[102:103], v[156:157] op_sel_hi:[1,0]
    ds_read_b64_tr_b16 a[124:125], v11 offset:20480
    v_pk_mul_f32 v[104:105], v[104:105], v[156:157] op_sel_hi:[1,0]
    ds_read_b64_tr_b16 a[126:127], v11 offset:22528
    buffer_load_dwordx4 v[32:35], v1, s[36:39], s88 offen offset:1024 sc1
    v_pk_mul_f32 v[106:107], v[106:107], v[156:157] op_sel_hi:[1,0]
    ds_read_b64_tr_b16 a[188:189], v12 offset:20480
    v_pk_mul_f32 v[108:109], v[108:109], v[158:159] op_sel_hi:[1,0]
    ds_read_b64_tr_b16 a[190:191], v12 offset:22528
    v_pk_mul_f32 v[110:111], v[110:111], v[158:159] op_sel_hi:[1,0]
    ds_read_b64_tr_b16 a[252:253], v24 offset:20480
    buffer_load_dwordx4 v[36:39], v1, s[36:39], s88 offen offset:2048 sc1
    v_pk_mul_f32 v[112:113], v[112:113], v[158:159] op_sel_hi:[1,0]
    ds_read_b64_tr_b16 a[254:255], v24 offset:22528
    v_pk_mul_f32 v[114:115], v[114:115], v[158:159] op_sel_hi:[1,0]
    v_xor_b32 v7, 8192, v7
    v_xor_b32 v11, 8192, v11
    v_xor_b32 v12, 8192, v12
    v_xor_b32 v24, 8192, v24
    ds_read_b64_tr_b16 a[0:1], v7 offset:16384
    v_pk_mul_f32 v[116:117], v[116:117], v[158:159] op_sel_hi:[1,0]
    ds_read_b64_tr_b16 a[2:3], v7 offset:18432
    buffer_load_dwordx4 v[40:43], v1, s[36:39], s88 offen offset:3072 sc1
    v_pk_mul_f32 v[118:119], v[118:119], v[158:159] op_sel_hi:[1,0]
    ds_read_b64_tr_b16 a[64:65], v11 offset:16384
    v_pk_mul_f32 v[120:121], v[120:121], v[158:159] op_sel_hi:[1,0]
    ds_read_b64_tr_b16 a[66:67], v11 offset:18432
    v_pk_mul_f32 v[122:123], v[122:123], v[158:159] op_sel_hi:[1,0]
    ds_read_b64_tr_b16 a[128:129], v12 offset:16384
    s_cbranch_vccz L_ok0
    s_call_b64 s[70:71], L_retry0
L_ok0:
    v_mfma_f32_16x16x32_bf16 v[108:111], a[8:11], v[232:235], v[108:111]
    ds_read_b64_tr_b16 a[130:131], v12 offset:18432
    v_mfma_f32_16x16x32_bf16 v[112:115], a[72:75], v[232:235], v[112:115]
    ds_read_b64_tr_b16 a[192:193], v24 offset:16384
    v_mfma_f32_16x16x32_bf16 v[116:119], a[136:139], v[232:235], v[116:119]
    ds_read_b64_tr_b16 a[194:195], v24 offset:18432
    v_mfma_f32_16x16x32_bf16 v[120:123], a[200:203], v[232:235], v[120:123]
    ds_read_b64_tr_b16 a[4:5], v7 offset:20480
    v_mfma_f32_16x16x32_bf16 v[108:111], a[12:15], v[236:239], v[108:111]
    ds_read_b64_tr_b16 a[6:7], v7 offset:22528
    v_mfma_f32_16x16x32_bf16 v[112:115], a[76:79], v[236:239], v[112:115]
    ds_read_b64_tr_b16 a[68:69], v11 offset:20480
    v_mfma_f32_16x16x32_bf16 v[116:119], a[140:143], v[236:239], v[116:119]
    ds_read_b64_tr_b16 a[70:71], v11 offset:22528
    v_mfma_f32_16x16x32_bf16 v[120:123], a[204:207], v[236:239], v[120:123]
    ds_read_b64_tr_b16 a[132:133], v12 offset:20480
    s_waitcnt lgkmcnt(15)
    v_mfma_f32_16x16x32_bf16 v[108:111], a[16:19], v[240:243], v[108:111]
    ds_read_b64_tr_b16 a[134:135], v12 offset:22528
    v_mfma_f32_16x16x32_bf16 v[112:115], a[80:83], v[240:243], v[112:115]
    ds_read_b64_tr_b16 a[196:197], v24 offset:20480
    v_mfma_f32_16x16x32_bf16 v[116:119], a[144:147], v[240:243], v[116:119]
    ds_read_b64_tr_b16 a[198:199], v24 offset:22528
    v_mfma_f32_16x16x32_bf16 v[120:123], a[208:211], v[240:243], v[120:123]
    v_mfma_f32_16x16x32_bf16 v[108:111], a[20:23], v[244:247], v[108:111]
    v_mfma_f32_16x16x32_bf16 v[112:115], a[84:87], v[244:247], v[112:115]
    v_mfma_f32_16x16x32_bf16 v[116:119], a[148:151], v[244:247], v[116:119]
    s_waitcnt vmcnt(8)
    v_mfma_f32_16x16x32_bf16 v[120:123], a[212:215], v[244:247], v[120:123]
    v_max3_u32 v23, v180, v181, v182
    v_mfma_f32_16x16x32_bf16 v[92:95], a[8:11], v[248:251], v[92:95]
    v_max3_u32 v23, v23, v183, v184
    v_mfma_f32_16x16x32_bf16 v[96:99], a[72:75], v[248:251], v[96:99]
    v_max3_u32 v23, v23, v185, v186
    v_mfma_f32_16x16x32_bf16 v[100:103], a[136:139], v[248:251], v[100:103]
    v_max3_u32 v23, v23, v187, v188
    v_mfma_f32_16x16x32_bf16 v[104:107], a[200:203], v[248:251], v[104:107]
    v_max3_u32 v23, v23, v189, v190
    v_mfma_f32_16x16x32_bf16 v[92:95], a[12:15], v[252:255], v[92:95]
    s_xor_b32 s88, s79, 0
    buffer_load_dwordx4 v[44:47], v1, s[36:39], s88 offen offset:0 sc1
    v_max3_u32 v23, v23, v191, v192
    v_mfma_f32_16x16x32_bf16 v[96:99], a[76:79], v[252:255], v[96:99]
    v_max3_u32 v23, v23, v193, v194
    buffer_load_dwordx4 v[48:51], v1, s[36:39], s88 offen offset:1024 sc1
    v_mfma_f32_16x16x32_bf16 v[100:103], a[140:143], v[252:255], v[100:103]
    v_max3_u32 v23, v23, v195, v196
    v_mfma_f32_16x16x32_bf16 v[104:107], a[204:207], v[252:255], v[104:107]
    s_xor_b32 s88, s79, 2048
    buffer_load_dwordx4 v[52:55], v1, s[36:39], s88 offen offset:0 sc1
    v_max3_u32 v23, v23, v197, v198
    v_mfma_f32_16x16x32_bf16 v[92:95], a[16:19], v[172:175], v[92:95]
    v_max3_u32 v23, v23, v199, v60
    buffer_load_dwordx4 v[56:59], v1, s[36:39], s88 offen offset:1024 sc1
    v_mfma_f32_16x16x32_bf16 v[96:99], a[80:83], v[172:175], v[96:99]
    v_max3_u32 v23, v23, v61, v62
    v_mfma_f32_16x16x32_bf16 v[100:103], a[144:147], v[172:175], v[100:103]
    v_max3_u32 v23, v23, v63, v64
    v_mfma_f32_16x16x32_bf16 v[104:107], a[208:211], v[172:175], v[104:107]
    v_max3_u32 v23, v23, v65, v66
    v_mfma_f32_16x16x32_bf16 v[92:95], a[20:23], v[176:179], v[92:95]
    v_max3_u32 v23, v23, v67, v68
    v_mfma_f32_16x16x32_bf16 v[96:99], a[84:87], v[176:179], v[96:99]
    v_max3_u32 v23, v23, v69, v70
    v_mfma_f32_16x16x32_bf16 v[100:103], a[148:151], v[176:179], v[100:103]
    v_max_u32 v23, v23, v71
    v_mfma_f32_16x16x32_bf16 v[104:107], a[212:215], v[176:179], v[104:107]
    v_cmp_eq_u32 vcc, -1, v23
    s_cbranch_vccz L_ok1
    s_call_b64 s[70:71], L_retry1
L_ok1:
    v_mfma_f32_16x16x32_bf16 v[108:111], a[24:27], v[180:183], v[108:111]
    v_mfma_f32_16x16x32_bf16 v[112:115], a[88:91], v[180:183], v[112:115]
    v_mfma_f32_16x16x32_bf16 v[116:119], a[152:155], v[180:183], v[116:119]
    v_mfma_f32_16x16x32_bf16 v[120:123], a[216:219], v[180:183], v[120:123]
    v_mfma_f32_16x16x32_bf16 v[108:111], a[28:31], v[184:187], v[108:111]
    v_mfma_f32_16x16x32_bf16 v[112:115], a[92:95], v[184:187], v[112:115]
    v_mfma_f32_16x16x32_bf16 v[116:119], a[156:159], v[184:187], v[116:119]
    v_mfma_f32_16x16x32_bf16 v[120:123], a[220:223], v[184:187], v[120:123]
    v_mfma_f32_16x16x32_bf16 v[108:111], a[32:35], v[188:191], v[108:111]
    v_mfma_f32_16x16x32_bf16 v[112:115], a[96:99], v[188:191], v[112:115]
    v_mfma_f32_16x16x32_bf16 v[116:119], a[160:163], v[188:191], v[116:119]
    v_mfma_f32_16x16x32_bf16 v[120:123], a[224:227], v[188:191], v[120:123]
    v_mfma_f32_16x16x32_bf16 v[108:111], a[36:39], v[192:195], v[108:111]
    v_mfma_f32_16x16x32_bf16 v[112:115], a[100:103], v[192:195], v[112:115]
    v_mfma_f32_16x16x32_bf16 v[116:119], a[164:167], v[192:195], v[116:119]
    s_waitcnt vmcnt(4)
    v_mfma_f32_16x16x32_bf16 v[120:123], a[228:231], v[192:195], v[120:123]
    v_max3_u32 v23, v72, v73, v74
    v_mfma_f32_16x16x32_bf16 v[92:95], a[24:27], v[196:199], v[92:95]
    v_max3_u32 v23, v23, v75, v76
    v_mfma_f32_16x16x32_bf16 v[96:99], a[88:91], v[196:199], v[96:99]
    v_max3_u32 v23, v23, v77, v78
    v_mfma_f32_16x16x32_bf16 v[100:103], a[152:155], v[196:199], v[100:103]
    v_max3_u32 v23, v23, v79, v80
    v_mfma_f32_16x16x32_bf16 v[104:107], a[216:219], v[196:199], v[104:107]
    v_max3_u32 v23, v23, v81, v82
    v_mfma_f32_16x16x32_bf16 v[92:95], a[28:31], v[60:63], v[92:95]
    v_max3_u32 v23, v23, v83, v84
    v_mfma_f32_16x16x32_bf16 v[96:99], a[92:95], v[60:63], v[96:99]
    v_max3_u32 v23, v23, v85, v86
    v_mfma_f32_16x16x32_bf16 v[100:103], a[156:159], v[60:63], v[100:103]
    v_max3_u32 v23, v23, v87, v88
    v_mfma_f32_16x16x32_bf16 v[104:107], a[220:223], v[60:63], v[104:107]
    v_max3_u32 v23, v23, v89, v90
    v_mfma_f32_16x16x32_bf16 v[92:95], a[32:35], v[64:67], v[92:95]
    v_max3_u32 v23, v23, v91, v32
    v_mfma_f32_16x16x32_bf16 v[96:99], a[96:99], v[64:67], v[96:99]
    v_max3_u32 v23, v23, v33, v34
    v_mfma_f32_16x16x32_bf16 v[100:103], a[160:163], v[64:67], v[100:103]
    v_max3_u32 v23, v23, v35, v36
    v_mfma_f32_16x16x32_bf16 v[104:107], a[224:227], v[64:67], v[104:107]
    v_max3_u32 v23, v23, v37, v38
    v_mfma_f32_16x16x32_bf16 v[92:95], a[36:39], v[68:71], v[92:95]
    v_max3_u32 v23, v23, v39, v40
    v_mfma_f32_16x16x32_bf16 v[96:99], a[100:103], v[68:71], v[96:99]
    v_max3_u32 v23, v23, v41, v42
    v_mfma_f32_16x16x32_bf16 v[100:103], a[164:167], v[68:71], v[100:103]
    v_max_u32 v23, v23, v43
    v_mfma_f32_16x16x32_bf16 v[104:107], a[228:231], v[68:71], v[104:107]
    v_cmp_eq_u32 vcc, -1, v23
    s_cbranch_vccz L_ok2
    s_call_b64 s[70:71], L_retry2
L_ok2:
    v_mfma_f32_16x16x32_bf16 v[108:111], a[40:43], v[72:75], v[108:111]
    s_mul_i32 s77, s54, 2304
    v_mfma_f32_16x16x32_bf16 v[112:115], a[104:107], v[72:75], v[112:115]
    s_add_u32 s77, s77, 49152
    v_mfma_f32_16x16x32_bf16 v[116:119], a[168:171], v[72:75], v[116:119]
    v_mul_u32_u24 v26, 144, v3
    v_mfma_f32_16x16x32_bf16 v[120:123], a[232:235], v[72:75], v[120:123]
    v_lshl_add_u32 v26, v4, 3, v26
    v_mfma_f32_16x16x32_bf16 v[108:111], a[44:47], v[76:79], v[108:111]
    v_add_u32 v26, s77, v26
    v_mfma_f32_16x16x32_bf16 v[112:115], a[108:111], v[76:79], v[112:115]
    v_lshrrev_b32 v15, 3, v0
    v_mfma_f32_16x16x32_bf16 v[116:119], a[172:175], v[76:79], v[116:119]
    v_and_b32 v17, 7, v0
    v_mfma_f32_16x16x32_bf16 v[120:123], a[236:239], v[76:79], v[120:123]
    v_mul_u32_u24 v27, 144, v15
    v_mfma_f32_16x16x32_bf16 v[108:111], a[48:51], v[80:83], v[108:111]
    v_lshl_add_u32 v27, v17, 4, v27
    v_mfma_f32_16x16x32_bf16 v[112:115], a[112:115], v[80:83], v[112:115]
    v_add_u32 v27, s77, v27
    v_mfma_f32_16x16x32_bf16 v[116:119], a[176:179], v[80:83], v[116:119]
    v_lshlrev_b32 v15, 17, v15
    v_mfma_f32_16x16x32_bf16 v[120:123], a[240:243], v[80:83], v[120:123]
    v_lshl_add_u32 v15, v17, 4, v15
    v_mfma_f32_16x16x32_bf16 v[108:111], a[52:55], v[84:87], v[108:111]
    v_mfma_f32_16x16x32_bf16 v[112:115], a[116:119], v[84:87], v[112:115]
    v_mfma_f32_16x16x32_bf16 v[116:119], a[180:183], v[84:87], v[116:119]
    v_mfma_f32_16x16x32_bf16 v[120:123], a[244:247], v[84:87], v[120:123]
    v_mfma_f32_16x16x32_bf16 v[92:95], a[40:43], v[88:91], v[92:95]
    v_mfma_f32_16x16x32_bf16 v[96:99], a[104:107], v[88:91], v[96:99]
    v_mfma_f32_16x16x32_bf16 v[100:103], a[168:171], v[88:91], v[100:103]
    s_nop 1
    ds_write_b128 v14, v[108:111] offset:32768
    v_mfma_f32_16x16x32_bf16 v[104:107], a[232:235], v[88:91], v[104:107]
    ds_write_b128 v14, v[112:115] offset:33792
    v_mfma_f32_16x16x32_bf16 v[92:95], a[44:47], v[32:35], v[92:95]
    ds_write_b128 v14, v[116:119] offset:34816
    v_mfma_f32_16x16x32_bf16 v[96:99], a[108:111], v[32:35], v[96:99]
    ds_write_b128 v14, v[120:123] offset:35840
    v_mfma_f32_16x16x32_bf16 v[100:103], a[172:175], v[32:35], v[100:103]
    s_waitcnt vmcnt(0)
    v_mfma_f32_16x16x32_bf16 v[104:107], a[236:239], v[32:35], v[104:107]
    v_max3_u32 v23, v44, v45, v46
    v_mfma_f32_16x16x32_bf16 v[92:95], a[48:51], v[36:39], v[92:95]
    v_max3_u32 v23, v23, v47, v48
    v_mfma_f32_16x16x32_bf16 v[96:99], a[112:115], v[36:39], v[96:99]
    v_max3_u32 v23, v23, v49, v50
    v_mfma_f32_16x16x32_bf16 v[100:103], a[176:179], v[36:39], v[100:103]
    v_max3_u32 v23, v23, v51, v52
    v_mfma_f32_16x16x32_bf16 v[104:107], a[240:243], v[36:39], v[104:107]
    v_max3_u32 v23, v23, v53, v54
    v_mfma_f32_16x16x32_bf16 v[92:95], a[52:55], v[40:43], v[92:95]
    v_max3_u32 v23, v23, v55, v56
    v_mfma_f32_16x16x32_bf16 v[96:99], a[116:119], v[40:43], v[96:99]
    v_max3_u32 v23, v23, v57, v58
    v_mfma_f32_16x16x32_bf16 v[100:103], a[180:183], v[40:43], v[100:103]
    v_max_u32 v23, v23, v59
    v_mfma_f32_16x16x32_bf16 v[104:107], a[244:247], v[40:43], v[104:107]
    v_cmp_eq_u32 vcc, -1, v23
    s_cbranch_vccz L_ok3
    s_call_b64 s[70:71], L_retry3
L_ok3:
    v_mfma_f32_16x16x32_bf16 v[92:95], a[56:59], v[44:47], v[92:95]
    v_mfma_f32_16x16x32_bf16 v[96:99], a[120:123], v[44:47], v[96:99]
    v_mfma_f32_16x16x32_bf16 v[100:103], a[184:187], v[44:47], v[100:103]
    v_mfma_f32_16x16x32_bf16 v[104:107], a[248:251], v[44:47], v[104:107]
    s_waitcnt lgkmcnt(0)
    s_barrier
    ds_read_b128 v[108:111], v16 offset:32768
    ds_read_b128 v[112:115], v16 offset:33792
    ds_read_b128 v[116:119], v16 offset:34816
    ds_read_b128 v[120:123], v16 offset:35840
    v_mfma_f32_16x16x32_bf16 v[92:95], a[60:63], v[48:51], v[92:95]
    v_mfma_f32_16x16x32_bf16 v[96:99], a[124:127], v[48:51], v[96:99]
    v_mfma_f32_16x16x32_bf16 v[100:103], a[188:191], v[48:51], v[100:103]
    v_mfma_f32_16x16x32_bf16 v[104:107], a[252:255], v[48:51], v[104:107]
    v_mfma_f32_16x16x32_bf16 v[92:95], a[0:3], v[52:55], v[92:95]
    v_mfma_f32_16x16x32_bf16 v[96:99], a[64:67], v[52:55], v[96:99]
    v_mfma_f32_16x16x32_bf16 v[100:103], a[128:131], v[52:55], v[100:103]
    v_mfma_f32_16x16x32_bf16 v[104:107], a[192:195], v[52:55], v[104:107]
    v_mfma_f32_16x16x32_bf16 v[92:95], a[4:7], v[56:59], v[92:95]
    v_mfma_f32_16x16x32_bf16 v[96:99], a[68:71], v[56:59], v[96:99]
    v_mfma_f32_16x16x32_bf16 v[100:103], a[132:135], v[56:59], v[100:103]
    v_mfma_f32_16x16x32_bf16 v[104:107], a[196:199], v[56:59], v[104:107]
    s_waitcnt lgkmcnt(0)
    s_nop 3
    v_pk_add_f32 v[92:93], v[92:93], v[108:109]
    v_pk_add_f32 v[94:95], v[94:95], v[110:111]
    v_cvt_pk_bf16_f32 v18, v92, v93
    v_cvt_pk_bf16_f32 v19, v94, v95
    ds_write_b64 v26, v[18:19] offset:0
    v_pk_add_f32 v[96:97], v[96:97], v[112:113]
    v_pk_add_f32 v[98:99], v[98:99], v[114:115]
    v_cvt_pk_bf16_f32 v20, v96, v97
    v_cvt_pk_bf16_f32 v21, v98, v99
    ds_write_b64 v26, v[20:21] offset:32
    v_pk_add_f32 v[100:101], v[100:101], v[116:117]
    v_pk_add_f32 v[102:103], v[102:103], v[118:119]
    v_cvt_pk_bf16_f32 v22, v100, v101
    v_cvt_pk_bf16_f32 v23, v102, v103
    ds_write_b64 v26, v[22:23] offset:64
    v_pk_add_f32 v[104:105], v[104:105], v[120:121]
    v_pk_add_f32 v[106:107], v[106:107], v[122:123]
    v_cvt_pk_bf16_f32 v24, v104, v105
    v_cvt_pk_bf16_f32 v25, v106, v107
    ds_write_b64 v26, v[24:25] offset:96
    s_waitcnt lgkmcnt(0)
    ds_read_b128 v[92:95], v27
    ds_read_b128 v[96:99], v27 offset:1152
    s_add_u32 s76, s81, 1048576
    s_waitcnt lgkmcnt(1)
    buffer_store_dwordx4 v[92:95], v15, s[32:35], s81 offen sc1
    s_waitcnt lgkmcnt(0)
    buffer_store_dwordx4 v[96:99], v15, s[32:35], s76 offen sc1
L_end:
    s_endpgm
L_retry0:
    s_add_u32 s76, s93, 0
    buffer_load_dwordx4 v[232:235], v1, s[36:39], s76 offen offset:0 sc1
    buffer_load_dwordx4 v[236:239], v1, s[36:39], s76 offen offset:1024 sc1
    buffer_load_dwordx4 v[240:243], v1, s[36:39], s76 offen offset:2048 sc1
    buffer_load_dwordx4 v[244:247], v1, s[36:39], s76 offen offset:3072 sc1
    s_add_u32 s76, s92, 0
    buffer_load_dwordx4 v[248:251], v1, s[36:39], s76 offen offset:0 sc1
    buffer_load_dwordx4 v[252:255], v1, s[36:39], s76 offen offset:1024 sc1
    buffer_load_dwordx4 v[172:175], v1, s[36:39], s76 offen offset:2048 sc1
    buffer_load_dwordx4 v[176:179], v1, s[36:39], s76 offen offset:3072 sc1
    s_waitcnt vmcnt(0)
    v_max3_u32 v23, v232, v233, v234
    v_max3_u32 v23, v23, v235, v236
    v_max3_u32 v23, v23, v237, v238
    v_max3_u32 v23, v23, v239, v240
    v_max3_u32 v23, v23, v241, v242
    v_max3_u32 v23, v23, v243, v244
    v_max3_u32 v23, v23, v245, v246
    v_max3_u32 v23, v23, v247, v248
    v_max3_u32 v23, v23, v249, v250
    v_max3_u32 v23, v23, v251, v252
    v_max3_u32 v23, v23, v253, v254
    v_max3_u32 v23, v23, v255, v172
    v_max3_u32 v23, v23, v173, v174
    v_max3_u32 v23, v23, v175, v176
    v_max3_u32 v23, v23, v177, v178
    v_max_u32 v23, v23, v179
    v_cmp_eq_u32 vcc, -1, v23
    s_add_u32 s82, s82, 1
    s_cmp_ge_u32 s82, 200000
    s_cbranch_scc1 L_retry0_r
    s_cbranch_vccnz L_retry0
L_retry0_r:
    s_setpc_b64 s[70:71]
L_retry1:
    s_add_u32 s76, s93, 8192
    buffer_load_dwordx4 v[180:183], v1, s[36:39], s76 offen offset:0 sc1
    buffer_load_dwordx4 v[184:187], v1, s[36:39], s76 offen offset:1024 sc1
    buffer_load_dwordx4 v[188:191], v1, s[36:39], s76 offen offset:2048 sc1
    buffer_load_dwordx4 v[192:195], v1, s[36:39], s76 offen offset:3072 sc1
    s_add_u32 s76, s92, 8192
    buffer_load_dwordx4 v[196:199], v1, s[36:39], s76 offen offset:0 sc1
    buffer_load_dwordx4 v[60:63], v1, s[36:39], s76 offen offset:1024 sc1
    buffer_load_dwordx4 v[64:67], v1, s[36:39], s76 offen offset:2048 sc1
    buffer_load_dwordx4 v[68:71], v1, s[36:39], s76 offen offset:3072 sc1
    s_waitcnt vmcnt(0)
    v_max3_u32 v23, v180, v181, v182
    v_max3_u32 v23, v23, v183, v184
    v_max3_u32 v23, v23, v185, v186
    v_max3_u32 v23, v23, v187, v188
    v_max3_u32 v23, v23, v189, v190
    v_max3_u32 v23, v23, v191, v192
    v_max3_u32 v23, v23, v193, v194
    v_max3_u32 v23, v23, v195, v196
    v_max3_u32 v23, v23, v197, v198
    v_max3_u32 v23, v23, v199, v60
    v_max3_u32 v23, v23, v61, v62
    v_max3_u32 v23, v23, v63, v64
    v_max3_u32 v23, v23, v65, v66
    v_max3_u32 v23, v23, v67, v68
    v_max3_u32 v23, v23, v69, v70
    v_max_u32 v23, v23, v71
    v_cmp_eq_u32 vcc, -1, v23
    s_add_u32 s82, s82, 1
    s_cmp_ge_u32 s82, 200000
    s_cbranch_scc1 L_retry1_r
    s_cbranch_vccnz L_retry1
L_retry1_r:
    s_setpc_b64 s[70:71]
L_retry2:
    s_add_u32 s76, s93, 16384
    buffer_load_dwordx4 v[72:75], v1, s[36:39], s76 offen offset:0 sc1
    buffer_load_dwordx4 v[76:79], v1, s[36:39], s76 offen offset:1024 sc1
    buffer_load_dwordx4 v[80:83], v1, s[36:39], s76 offen offset:2048 sc1
    buffer_load_dwordx4 v[84:87], v1, s[36:39], s76 offen offset:3072 sc1
    s_add_u32 s76, s92, 16384
    buffer_load_dwordx4 v[88:91], v1, s[36:39], s76 offen offset:0 sc1
    buffer_load_dwordx4 v[32:35], v1, s[36:39], s76 offen offset:1024 sc1
    buffer_load_dwordx4 v[36:39], v1, s[36:39], s76 offen offset:2048 sc1
    buffer_load_dwordx4 v[40:43], v1, s[36:39], s76 offen offset:3072 sc1
    s_waitcnt vmcnt(0)
    v_max3_u32 v23, v72, v73, v74
    v_max3_u32 v23, v23, v75, v76
    v_max3_u32 v23, v23, v77, v78
    v_max3_u32 v23, v23, v79, v80
    v_max3_u32 v23, v23, v81, v82
    v_max3_u32 v23, v23, v83, v84
    v_max3_u32 v23, v23, v85, v86
    v_max3_u32 v23, v23, v87, v88
    v_max3_u32 v23, v23, v89, v90
    v_max3_u32 v23, v23, v91, v32
    v_max3_u32 v23, v23, v33, v34
    v_max3_u32 v23, v23, v35, v36
    v_max3_u32 v23, v23, v37, v38
    v_max3_u32 v23, v23, v39, v40
    v_max3_u32 v23, v23, v41, v42
    v_max_u32 v23, v23, v43
    v_cmp_eq_u32 vcc, -1, v23
    s_add_u32 s82, s82, 1
    s_cmp_ge_u32 s82, 200000
    s_cbranch_scc1 L_retry2_r
    s_cbranch_vccnz L_retry2
L_retry2_r:
    s_setpc_b64 s[70:71]
L_retry3:
    s_xor_b32 s76, s79, 0
    buffer_load_dwordx4 v[44:47], v1, s[36:39], s76 offen offset:0 sc1
    buffer_load_dwordx4 v[48:51], v1, s[36:39], s76 offen offset:1024 sc1
    s_xor_b32 s76, s79, 2048
    buffer_load_dwordx4 v[52:55], v1, s[36:39], s76 offen offset:0 sc1
    buffer_load_dwordx4 v[56:59], v1, s[36:39], s76 offen offset:1024 sc1
    s_waitcnt vmcnt(0)
    v_max3_u32 v23, v44, v45, v46
    v_max3_u32 v23, v23, v47, v48
    v_max3_u32 v23, v23, v49, v50
    v_max3_u32 v23, v23, v51, v52
    v_max3_u32 v23, v23, v53, v54
    v_max3_u32 v23, v23, v55, v56
    v_max3_u32 v23, v23, v57, v58
    v_max_u32 v23, v23, v59
    v_cmp_eq_u32 vcc, -1, v23
    s_add_u32 s82, s82, 1
    s_cmp_ge_u32 s82, 200000
    s_cbranch_scc1 L_retry3_r
    s_cbranch_vccnz L_retry3
L_retry3_r:
    s_setpc_b64 s[70:71]
.section .rodata,"a"
.p2align 6
.amdhsa_kernel gated_mix__spectral_fnet__mixer_gmlp__prompt_kernel
  .amdhsa_next_free_vgpr 512
  .amdhsa_next_free_sgpr 102
  .amdhsa_accum_offset 256
  .amdhsa_group_segment_fixed_size 0
  .amdhsa_kernarg_size 112
  .amdhsa_user_sgpr_count 2
  .amdhsa_user_sgpr_kernarg_segment_ptr 1
  .amdhsa_system_sgpr_workgroup_id_x 1
.end_amdhsa_kernel
```
